```python
import torch

def _softmax(x, axis=-1):
    return torch.softmax(x, dim=axis)
def _gelu(x):
    return torch.nn.functional.gelu(x, approximate="tanh")
def _silu(x):
    return torch.nn.functional.silu(x)
def _sigmoid(x):
    return torch.sigmoid(x)
def _layernorm(x, axis=-1, eps=1e-5):
    m = x.mean(dim=axis, keepdim=True)
    v = x.var(dim=axis, keepdim=True, unbiased=False)
    return (x - m) / torch.sqrt(v + eps)
def _scatter_add(tgt, idx, src, axis=0):
    return tgt.clone().index_add_(axis, idx, src)
def _segment_sum(src, seg, n):
    out = torch.zeros((n,) + src.shape[1:], dtype=src.dtype)
    return out.index_add_(0, seg, src)
def _pad(x, pw):
    flat = tuple(v for pair in reversed(pw) for v in pair)
    return torch.nn.functional.pad(x, flat)

kernel_name = 'standalone__low_rank_proj_linformer__decode'

def setup_inputs():

    _w = (lambda a: (lambda t: t.to(torch.bfloat16) if t.is_floating_point() else t)(torch.as_tensor(a)))
    B, H, Sq, Skv, Dh, R = 1, 32, 1, 4096, 192, 64
    return {
        "q": _w((lambda *s: torch.randn(*s, dtype=torch.bfloat16) * 0.8)(B, H, Sq, Dh)),
        "k": _w((lambda *s: torch.randn(*s, dtype=torch.bfloat16) * 0.8)(B, H, Skv, Dh)),
        "v": _w((lambda *s: torch.randn(*s, dtype=torch.bfloat16) * 0.05)(B, H, Skv, Dh)),
        "e_proj": _w((lambda *s: torch.randn(*s, dtype=torch.bfloat16) * 0.8)(R, Skv) * (Skv ** -0.5)),
        "f_proj": _w((lambda *s: torch.randn(*s, dtype=torch.bfloat16) * 0.05)(R, Skv) * (Skv ** -0.5)),
    }

def reference(q, k, v, e_proj, f_proj):
    B, H, Sq, Dh = q.shape
    kp = torch.einsum("rn,bhnd->bhrd", e_proj, k)
    vp = torch.einsum("rn,bhnd->bhrd", f_proj, v)
    scores = torch.einsum("bhqd,bhrd->bhqr", q, kp) * (Dh ** -0.5)
    p = _softmax(scores, axis=-1)
    o = torch.einsum("bhqr,bhrd->bhqd", p, vp)
    return o
```

```asm
; @launch grid=(256,1,1) block=(256,1,1) lds=147520
.amdgcn_target "amdgcn-amd-amdhsa--gfx950"
.text
.globl standalone__low_rank_proj_linformer__decode_kernel
.p2align 8
.type standalone__low_rank_proj_linformer__decode_kernel,@function
standalone__low_rank_proj_linformer__decode_kernel:
  s_cmp_ge_u32 s2, 256
  s_cbranch_scc1 L_end
  s_load_dwordx16 s[24:39], s[0:1], 0
  v_lshrrev_b32 v20, 6, v0
  v_and_b32 v0, 63, v0
  v_readfirstlane_b32 s3, v20
  s_movk_i32 s60, 2731
  v_mov_b32 v20, v0
  v_mul_u32_u24 v20, s60, v20
  v_lshrrev_b32 v20, 17, v20
  v_xor_b32 v20, v20, v0
  v_lshlrev_b32 v1, 4, v20
  v_xor_b32 v4, 64, v1
  v_add_u32 v20, 64, v0
  v_mul_u32_u24 v20, s60, v20
  v_lshrrev_b32 v20, 17, v20
  v_xor_b32 v20, v20, v0
  v_lshlrev_b32 v2, 4, v20
  v_xor_b32 v5, 64, v2
  v_add_u32 v20, 128, v0
  v_mul_u32_u24 v20, s60, v20
  v_lshrrev_b32 v20, 17, v20
  v_xor_b32 v20, v20, v0
  v_lshlrev_b32 v3, 4, v20
  v_xor_b32 v6, 64, v3
  s_mov_b32 s59, 0
  s_bfe_u32 s60, s2, 0x30000
  s_lshl_b32 s60, s60, 3
  s_or_b32 s59, s59, s60
  s_bfe_u32 s60, s3, 0x10000
  s_lshl_b32 s60, s60, 0
  s_or_b32 s59, s59, s60
  s_bfe_u32 s60, s3, 0x10001
  s_lshl_b32 s60, s60, 2
  s_or_b32 s59, s59, s60
  s_lshr_b32 s56, s2, 3
  s_mul_i32 s56, s56, 1572864
  s_mul_i32 s60, s59, 24576
  s_add_u32 s56, s56, s60
  s_lshl_b32 s59, s59, 7
  s_mul_i32 s58, s3, 34816
  s_and_b32 s61, s2, 7
  s_lshr_b32 s62, s2, 3
  s_mov_b32 s10, 50331648
  s_mov_b32 s11, 0x20000
  s_mov_b32 s18, 524288
  s_mov_b32 s19, 0x20000
  s_mov_b32 s54, 12288
  s_mov_b32 s55, 0x20000
  s_mul_i32 s67, s62, 384
  v_lshrrev_b32 v20, 3, v0
  v_lshlrev_b32 v20, 13, v20
  v_lshrrev_b32 v21, 4, v0
  v_and_b32 v22, 7, v0
  v_xor_b32 v22, v22, v21
  v_lshl_add_u32 v10, v22, 4, v20
  v_xor_b32 v11, 64, v10
  v_lshlrev_b32 v23, 4, v21
  s_waitcnt lgkmcnt(0)
  s_mov_b32 s8, s26
  s_mov_b32 s9, s27
  s_mov_b32 s16, s30
  s_mov_b32 s17, s31
  s_mov_b32 s52, s24
  s_mov_b32 s53, s25
  s_add_u32 m0, s58, 16384
  s_add_u32 s57, s56, 0
  buffer_load_dwordx4 v1, s[8:11], s57 offen offset:0 sc0 nt lds
  buffer_load_dwordx4 v2, s[8:11], s57 offen offset:1024 sc0 nt lds
  buffer_load_dwordx4 v3, s[8:11], s57 offen offset:2048 sc0 nt lds
  buffer_load_dwordx4 a[0:3], v23, s[52:55], s67 offen offset:0
  buffer_load_dwordx4 a[4:7], v23, s[52:55], s67 offen offset:64
  buffer_load_dwordx4 a[8:11], v23, s[52:55], s67 offen offset:128
  buffer_load_dwordx4 a[12:15], v23, s[52:55], s67 offen offset:192
  buffer_load_dwordx4 a[16:19], v23, s[52:55], s67 offen offset:256
  buffer_load_dwordx4 a[20:23], v23, s[52:55], s67 offen offset:320
  s_add_u32 m0, s58, 19456
  s_add_u32 s57, s56, 3072
  buffer_load_dwordx4 v4, s[8:11], s57 offen offset:0 sc0 nt lds
  buffer_load_dwordx4 v5, s[8:11], s57 offen offset:1024 sc0 nt lds
  buffer_load_dwordx4 v6, s[8:11], s57 offen offset:2048 sc0 nt lds
  s_or_b32 s60, s3, s61
  s_cmp_eq_u32 s60, 0
  s_cbranch_scc0 L_pro0
  s_mov_b32 s40, s38
  s_mov_b32 s41, s39
  s_mov_b32 s42, 462848
  s_mov_b32 s43, 0x20000
  s_lshl_b32 s63, s2, 9
  v_mov_b32 v22, 4
  buffer_load_dword v30, v22, s[40:43], s63 offen sc1
L_pro0:
  s_add_u32 m0, s58, 22528
  s_add_u32 s57, s56, 6144
  buffer_load_dwordx4 v1, s[8:11], s57 offen offset:0 sc0 nt lds
  buffer_load_dwordx4 v2, s[8:11], s57 offen offset:1024 sc0 nt lds
  buffer_load_dwordx4 v3, s[8:11], s57 offen offset:2048 sc0 nt lds
  s_add_u32 m0, s58, 25600
  s_add_u32 s57, s56, 9216
  buffer_load_dwordx4 v4, s[8:11], s57 offen offset:0 sc0 nt lds
  buffer_load_dwordx4 v5, s[8:11], s57 offen offset:1024 sc0 nt lds
  buffer_load_dwordx4 v6, s[8:11], s57 offen offset:2048 sc0 nt lds
  s_add_u32 m0, s58, 0
  s_add_u32 s57, s59, 0
  buffer_load_dwordx4 v10, s[16:19], s57 offen offset:0 lds
  s_add_u32 m0, s58, 28672
  s_add_u32 s57, s56, 12288
  buffer_load_dwordx4 v1, s[8:11], s57 offen offset:0 sc0 nt lds
  buffer_load_dwordx4 v2, s[8:11], s57 offen offset:1024 sc0 nt lds
  buffer_load_dwordx4 v3, s[8:11], s57 offen offset:2048 sc0 nt lds
  s_add_u32 m0, s58, 31744
  s_add_u32 s57, s56, 15360
  buffer_load_dwordx4 v4, s[8:11], s57 offen offset:0 sc0 nt lds
  buffer_load_dwordx4 v5, s[8:11], s57 offen offset:1024 sc0 nt lds
  buffer_load_dwordx4 v6, s[8:11], s57 offen offset:2048 sc0 nt lds
  s_add_u32 m0, s58, 0
  s_add_u32 s57, s59, 64512
  buffer_load_dwordx4 v11, s[16:19], s57 offen offset:1024 lds
  s_mov_b32 s12, s28
  s_mov_b32 s13, s29
  s_mov_b32 s14, 50331648
  s_mov_b32 s15, 0x20000
  s_mov_b32 s20, s32
  s_mov_b32 s21, s33
  s_mov_b32 s22, 524288
  s_mov_b32 s23, 0x20000
  s_mov_b32 s40, s38
  s_mov_b32 s41, s39
  s_mov_b32 s42, 462848
  s_mov_b32 s43, 0x20000
  s_mov_b32 s44, s34
  s_mov_b32 s45, s35
  s_mov_b32 s46, 12288
  s_mov_b32 s47, 0x20000
  s_mov_b32 s48, s36
  s_mov_b32 s49, s37
  s_mov_b32 s50, 256
  s_mov_b32 s51, 0x20000
  s_lshl_b32 s63, s2, 9
  s_mul_i32 s64, s2, 768
  s_add_u32 s64, s64, 131072
  s_cmp_eq_u32 s3, 0
  s_cbranch_scc0 L_pro1
  v_mov_b32 v24, -1
  v_mov_b32 v25, -1
  v_mov_b32 v26, -1
  v_mov_b32 v27, -1
  v_lshlrev_b32 v22, 4, v0
  s_mov_b32 exec_lo, -1
  s_mov_b32 exec_hi, 0xffff
  buffer_store_dwordx4 v[24:27], v22, s[40:43], s64 offen sc1
  s_mov_b64 exec, -1
  s_nop 1
  v_mov_b32 v24, 0
  v_mov_b32 v25, 0
  v_mov_b32 v22, 147456
  ds_write_b64 v22, v[24:25]
L_pro1:
  s_mov_b32 s90, 0xaaaaaaaa
  s_mov_b32 s91, 0xaaaaaaaa
  s_mov_b32 s92, 0xffff0000
  s_mov_b32 s93, 0xffff0000
  s_mov_b32 s94, 0
  s_mov_b32 s95, -1
  v_lshlrev_b32 v20, 4, v0
  v_xor_b32 v21, 64, v20
  s_mov_b32 vcc_lo, 0
  s_mov_b32 vcc_hi, 0xffff0000
  v_cndmask_b32 v7, v20, v21, vcc
  s_mov_b32 vcc_lo, -1
  s_mov_b32 vcc_hi, 0
  v_cndmask_b32 v8, v20, v21, vcc
  s_mov_b32 vcc_lo, 0xffff0000
  s_mov_b32 vcc_hi, -1
  v_cndmask_b32 v9, v20, v21, vcc
  v_and_b32 v20, 15, v0
  v_mul_u32_u24 v21, 384, v20
  v_lshrrev_b32 v20, 1, v20
  v_lshrrev_b32 v22, 4, v0
  v_xor_b32 v20, v20, v22
  v_lshl_add_u32 v20, v20, 4, v21
  s_add_u32 s60, s58, 16384
  v_add_u32 v18, s60, v20
  v_xor_b32 v20, 64, v20
  v_add_u32 v19, s60, v20
  v_lshrrev_b32 v20, 5, v0
  v_lshlrev_b32 v20, 3, v20
  v_bfe_u32 v21, v0, 2, 2
  v_add_u32 v20, v20, v21
  v_mul_u32_u24 v20, 384, v20
  v_bfe_u32 v21, v0, 4, 1
  v_lshl_add_u32 v20, v21, 5, v20
  v_and_b32 v21, 3, v0
  v_lshl_add_u32 v20, v21, 3, v20
  v_add_u32 v20, s60, v20
  v_bfe_u32 v21, v0, 3, 1
  v_lshlrev_b32 v21, 6, v21
  v_add_u32 v12, v20, v21
  v_sub_u32 v13, v20, v21
  v_and_b32 v20, 31, v0
  v_bfe_u32 v21, v0, 1, 3
  v_lshrrev_b32 v22, 5, v0
  v_xor_b32 v21, v21, v22
  v_lshlrev_b32 v21, 4, v21
  v_lshl_add_u32 v20, v20, 7, v21
  v_add_u32 v14, s58, v20
  v_xor_b32 v15, 32, v14
  v_xor_b32 v16, 64, v14
  v_xor_b32 v17, 96, v14
  s_waitcnt lgkmcnt(0)
  s_barrier
  v_mov_b32 v29, 0
  s_waitcnt vmcnt(14)
  ds_read_b128 v[64:67], v18 offset:0
  ds_read_b128 v[68:71], v19 offset:0
  ds_read_b128 v[72:75], v18 offset:128
  ds_read_b128 v[76:79], v19 offset:128
  ds_read_b128 v[80:83], v18 offset:256
  ds_read_b128 v[84:87], v19 offset:256
  s_waitcnt lgkmcnt(5)
  v_mfma_f32_16x16x32_bf16 v[88:91], v[64:67], a[0:3], 0
  s_waitcnt lgkmcnt(4)
  v_mfma_f32_16x16x32_bf16 v[88:91], v[68:71], a[4:7], v[88:91]
  s_waitcnt lgkmcnt(3)
  v_mfma_f32_16x16x32_bf16 v[88:91], v[72:75], a[8:11], v[88:91]
  s_waitcnt lgkmcnt(2)
  v_mfma_f32_16x16x32_bf16 v[88:91], v[76:79], a[12:15], v[88:91]
  s_waitcnt lgkmcnt(1)
  v_mfma_f32_16x16x32_bf16 v[88:91], v[80:83], a[16:19], v[88:91]
  s_waitcnt lgkmcnt(0)
  v_mfma_f32_16x16x32_bf16 v[88:91], v[84:87], a[20:23], v[88:91]
  s_add_u32 m0, s58, 16384
  s_add_u32 s57, s56, 18432
  buffer_load_dwordx4 v1, s[8:11], s57 offen offset:0 sc0 nt lds
  buffer_load_dwordx4 v2, s[8:11], s57 offen offset:1024 sc0 nt lds
  buffer_load_dwordx4 v3, s[8:11], s57 offen offset:2048 sc0 nt lds
  s_add_u32 m0, s58, 19456
  s_add_u32 s57, s56, 21504
  buffer_load_dwordx4 v4, s[8:11], s57 offen offset:0 sc0 nt lds
  buffer_load_dwordx4 v5, s[8:11], s57 offen offset:1024 sc0 nt lds
  buffer_load_dwordx4 v6, s[8:11], s57 offen offset:2048 sc0 nt lds
  s_add_u32 m0, s58, 0
  s_add_u32 s57, s59, 129024
  buffer_load_dwordx4 v10, s[16:19], s57 offen offset:2048 lds
  s_add_u32 s57, s59, 193536
  buffer_load_dwordx4 v11, s[16:19], s57 offen offset:3072 lds
  s_add_u32 m0, s58, 4096
  s_add_u32 s57, s59, 262144
  buffer_load_dwordx4 v10, s[16:19], s57 offen offset:0 lds
  s_nop 1
  v_and_b32 v20, 0xffff0000, v88
  v_and_b32 v21, 0xffff0000, v89
  v_and_b32 v22, 0xffff0000, v90
  v_and_b32 v23, 0xffff0000, v91
  v_sub_f32 v24, v88, v20
  v_sub_f32 v25, v89, v21
  v_sub_f32 v26, v90, v22
  v_sub_f32 v27, v91, v23
  v_cndmask_b32 v20, v20, v24, s[90:91]
  v_cndmask_b32 v21, v21, v25, s[90:91]
  v_cndmask_b32 v22, v22, v26, s[90:91]
  v_cndmask_b32 v23, v23, v27, s[90:91]
  v_cvt_pk_bf16_f32 v92, v20, v21
  v_cvt_pk_bf16_f32 v93, v22, v23
  s_waitcnt vmcnt(17)
  s_or_b32 s60, s3, s61
  s_cmp_eq_u32 s60, 0
  s_cbranch_scc0 L_n1
  s_mov_b32 s60, 0x9E3779B1
  v_mul_lo_u32 v30, v30, s60
  v_add_u32 v30, 0x632BE5AB, v30
  v_or_b32 v24, 1, v30
  s_lshl_b32 s60, s62, 2
  s_add_u32 s60, s60, 128
  v_mov_b32 v22, 0
  s_mov_b64 exec, 1
  buffer_store_dword v24, v22, s[48:51], s60 offen sc1
  s_mov_b64 exec, -1
L_n1:
  ds_read_b128 v[64:67], v18 offset:6144
  ds_read_b128 v[68:71], v19 offset:6144
  ds_read_b128 v[72:75], v18 offset:6272
  ds_read_b128 v[76:79], v19 offset:6272
  ds_read_b128 v[80:83], v18 offset:6400
  ds_read_b128 v[84:87], v19 offset:6400
  s_waitcnt lgkmcnt(5)
  v_mfma_f32_16x16x32_bf16 v[88:91], v[64:67], a[0:3], 0
  s_waitcnt lgkmcnt(4)
  v_mfma_f32_16x16x32_bf16 v[88:91], v[68:71], a[4:7], v[88:91]
  s_waitcnt lgkmcnt(3)
  v_mfma_f32_16x16x32_bf16 v[88:91], v[72:75], a[8:11], v[88:91]
  s_waitcnt lgkmcnt(2)
  v_mfma_f32_16x16x32_bf16 v[88:91], v[76:79], a[12:15], v[88:91]
  s_waitcnt lgkmcnt(1)
  v_mfma_f32_16x16x32_bf16 v[88:91], v[80:83], a[16:19], v[88:91]
  s_waitcnt lgkmcnt(0)
  v_mfma_f32_16x16x32_bf16 v[88:91], v[84:87], a[20:23], v[88:91]
  s_add_u32 m0, s58, 22528
  s_add_u32 s57, s56, 49152
  buffer_load_dwordx4 v1, s[8:11], s57 offen offset:0 sc0 nt lds
  buffer_load_dwordx4 v2, s[8:11], s57 offen offset:1024 sc0 nt lds
  buffer_load_dwordx4 v3, s[8:11], s57 offen offset:2048 sc0 nt lds
  s_add_u32 m0, s58, 25600
  s_add_u32 s57, s56, 52224
  buffer_load_dwordx4 v4, s[8:11], s57 offen offset:0 sc0 nt lds
  buffer_load_dwordx4 v5, s[8:11], s57 offen offset:1024 sc0 nt lds
  buffer_load_dwordx4 v6, s[8:11], s57 offen offset:2048 sc0 nt lds
  s_add_u32 m0, s58, 4096
  s_add_u32 s57, s59, 326656
  buffer_load_dwordx4 v11, s[16:19], s57 offen offset:1024 lds
  s_add_u32 s57, s59, 391168
  buffer_load_dwordx4 v10, s[16:19], s57 offen offset:2048 lds
  s_add_u32 s57, s59, 455680
  buffer_load_dwordx4 v11, s[16:19], s57 offen offset:3072 lds
  s_nop 1
  v_and_b32 v20, 0xffff0000, v88
  v_and_b32 v21, 0xffff0000, v89
  v_and_b32 v22, 0xffff0000, v90
  v_and_b32 v23, 0xffff0000, v91
  v_sub_f32 v24, v88, v20
  v_sub_f32 v25, v89, v21
  v_sub_f32 v26, v90, v22
  v_sub_f32 v27, v91, v23
  v_cndmask_b32 v20, v20, v24, s[90:91]
  v_cndmask_b32 v21, v21, v25, s[90:91]
  v_cndmask_b32 v22, v22, v26, s[90:91]
  v_cndmask_b32 v23, v23, v27, s[90:91]
  v_cvt_pk_bf16_f32 v94, v20, v21
  v_cvt_pk_bf16_f32 v95, v22, v23
  s_waitcnt vmcnt(19)
  ds_read_b128 v[64:67], v18 offset:12288
  ds_read_b128 v[68:71], v19 offset:12288
  ds_read_b128 v[72:75], v18 offset:12416
  ds_read_b128 v[76:79], v19 offset:12416
  ds_read_b128 v[80:83], v18 offset:12544
  ds_read_b128 v[84:87], v19 offset:12544
  s_waitcnt lgkmcnt(5)
  v_mfma_f32_16x16x32_bf16 v[88:91], v[64:67], a[0:3], 0
  s_waitcnt lgkmcnt(4)
  v_mfma_f32_16x16x32_bf16 v[88:91], v[68:71], a[4:7], v[88:91]
  s_waitcnt lgkmcnt(3)
  v_mfma_f32_16x16x32_bf16 v[88:91], v[72:75], a[8:11], v[88:91]
  s_waitcnt lgkmcnt(2)
  v_mfma_f32_16x16x32_bf16 v[88:91], v[76:79], a[12:15], v[88:91]
  s_waitcnt lgkmcnt(1)
  v_mfma_f32_16x16x32_bf16 v[88:91], v[80:83], a[16:19], v[88:91]
  s_waitcnt lgkmcnt(0)
  v_mfma_f32_16x16x32_bf16 v[88:91], v[84:87], a[20:23], v[88:91]
  s_add_u32 m0, s58, 28672
  s_add_u32 s57, s56, 55296
  buffer_load_dwordx4 v1, s[8:11], s57 offen offset:0 sc0 nt lds
  buffer_load_dwordx4 v2, s[8:11], s57 offen offset:1024 sc0 nt lds
  buffer_load_dwordx4 v3, s[8:11], s57 offen offset:2048 sc0 nt lds
  s_add_u32 m0, s58, 31744
  s_add_u32 s57, s56, 58368
  buffer_load_dwordx4 v4, s[8:11], s57 offen offset:0 sc0 nt lds
  buffer_load_dwordx4 v5, s[8:11], s57 offen offset:1024 sc0 nt lds
  buffer_load_dwordx4 v6, s[8:11], s57 offen offset:2048 sc0 nt lds
  s_add_u32 m0, s58, 8192
  s_add_u32 s57, s59, 256
  buffer_load_dwordx4 v10, s[16:19], s57 offen offset:0 lds
  s_add_u32 s57, s59, 64768
  buffer_load_dwordx4 v11, s[16:19], s57 offen offset:1024 lds
  s_add_u32 s57, s59, 129280
  buffer_load_dwordx4 v10, s[16:19], s57 offen offset:2048 lds
  s_add_u32 s57, s59, 193792
  buffer_load_dwordx4 v11, s[16:19], s57 offen offset:3072 lds
  s_nop 1
  v_and_b32 v20, 0xffff0000, v88
  v_and_b32 v21, 0xffff0000, v89
  v_and_b32 v22, 0xffff0000, v90
  v_and_b32 v23, 0xffff0000, v91
  v_sub_f32 v24, v88, v20
  v_sub_f32 v25, v89, v21
  v_sub_f32 v26, v90, v22
  v_sub_f32 v27, v91, v23
  v_cndmask_b32 v20, v20, v24, s[90:91]
  v_cndmask_b32 v21, v21, v25, s[90:91]
  v_cndmask_b32 v22, v22, v26, s[90:91]
  v_cndmask_b32 v23, v23, v27, s[90:91]
  v_cvt_pk_bf16_f32 v96, v20, v21
  v_cvt_pk_bf16_f32 v97, v22, v23
  s_waitcnt vmcnt(22)
  ds_read_b128 v[64:67], v18 offset:0
  ds_read_b128 v[68:71], v19 offset:0
  ds_read_b128 v[72:75], v18 offset:128
  ds_read_b128 v[76:79], v19 offset:128
  ds_read_b128 v[80:83], v18 offset:256
  ds_read_b128 v[84:87], v19 offset:256
  s_waitcnt lgkmcnt(5)
  v_mfma_f32_16x16x32_bf16 v[88:91], v[64:67], a[0:3], 0
  s_waitcnt lgkmcnt(4)
  v_mfma_f32_16x16x32_bf16 v[88:91], v[68:71], a[4:7], v[88:91]
  s_waitcnt lgkmcnt(3)
  v_mfma_f32_16x16x32_bf16 v[88:91], v[72:75], a[8:11], v[88:91]
  s_waitcnt lgkmcnt(2)
  v_mfma_f32_16x16x32_bf16 v[88:91], v[76:79], a[12:15], v[88:91]
  s_waitcnt lgkmcnt(1)
  v_mfma_f32_16x16x32_bf16 v[88:91], v[80:83], a[16:19], v[88:91]
  s_waitcnt lgkmcnt(0)
  v_mfma_f32_16x16x32_bf16 v[88:91], v[84:87], a[20:23], v[88:91]
  s_add_u32 m0, s58, 16384
  s_add_u32 s57, s56, 61440
  buffer_load_dwordx4 v1, s[8:11], s57 offen offset:0 sc0 nt lds
  buffer_load_dwordx4 v2, s[8:11], s57 offen offset:1024 sc0 nt lds
  buffer_load_dwordx4 v3, s[8:11], s57 offen offset:2048 sc0 nt lds
  s_add_u32 m0, s58, 19456
  s_add_u32 s57, s56, 64512
  buffer_load_dwordx4 v4, s[8:11], s57 offen offset:0 sc0 nt lds
  buffer_load_dwordx4 v5, s[8:11], s57 offen offset:1024 sc0 nt lds
  buffer_load_dwordx4 v6, s[8:11], s57 offen offset:2048 sc0 nt lds
  s_add_u32 m0, s58, 12288
  s_add_u32 s57, s59, 262400
  buffer_load_dwordx4 v10, s[16:19], s57 offen offset:0 lds
  s_add_u32 s57, s59, 326912
  buffer_load_dwordx4 v11, s[16:19], s57 offen offset:1024 lds
  s_add_u32 s57, s59, 391424
  buffer_load_dwordx4 v10, s[16:19], s57 offen offset:2048 lds
  s_add_u32 s57, s59, 455936
  buffer_load_dwordx4 v11, s[16:19], s57 offen offset:3072 lds
  s_nop 1
  v_and_b32 v20, 0xffff0000, v88
  v_and_b32 v21, 0xffff0000, v89
  v_and_b32 v22, 0xffff0000, v90
  v_and_b32 v23, 0xffff0000, v91
  v_sub_f32 v24, v88, v20
  v_sub_f32 v25, v89, v21
  v_sub_f32 v26, v90, v22
  v_sub_f32 v27, v91, v23
  v_cndmask_b32 v20, v20, v24, s[90:91]
  v_cndmask_b32 v21, v21, v25, s[90:91]
  v_cndmask_b32 v22, v22, v26, s[90:91]
  v_cndmask_b32 v23, v23, v27, s[90:91]
  v_cvt_pk_bf16_f32 v98, v20, v21
  v_cvt_pk_bf16_f32 v99, v22, v23
  s_waitcnt vmcnt(23)
  ds_read_b128 v[64:67], v18 offset:6144
  ds_read_b128 v[68:71], v19 offset:6144
  ds_read_b128 v[72:75], v18 offset:6272
  ds_read_b128 v[76:79], v19 offset:6272
  ds_read_b128 v[80:83], v18 offset:6400
  ds_read_b128 v[84:87], v19 offset:6400
  s_waitcnt lgkmcnt(5)
  v_mfma_f32_16x16x32_bf16 v[88:91], v[64:67], a[0:3], 0
  s_waitcnt lgkmcnt(4)
  v_mfma_f32_16x16x32_bf16 v[88:91], v[68:71], a[4:7], v[88:91]
  s_waitcnt lgkmcnt(3)
  v_mfma_f32_16x16x32_bf16 v[88:91], v[72:75], a[8:11], v[88:91]
  s_waitcnt lgkmcnt(2)
  v_mfma_f32_16x16x32_bf16 v[88:91], v[76:79], a[12:15], v[88:91]
  s_waitcnt lgkmcnt(1)
  v_mfma_f32_16x16x32_bf16 v[88:91], v[80:83], a[16:19], v[88:91]
  s_waitcnt lgkmcnt(0)
  v_mfma_f32_16x16x32_bf16 v[88:91], v[84:87], a[20:23], v[88:91]
  s_lshl_b32 s60, s62, 2
  s_add_u32 s60, s60, 128
  v_mov_b32 v30, 0
  buffer_load_dword v31, v30, s[48:51], s60 offen sc1
  s_add_u32 m0, s58, 22528
  s_add_u32 s57, s56, 67584
  buffer_load_dwordx4 v1, s[8:11], s57 offen offset:0 sc0 nt lds
  buffer_load_dwordx4 v2, s[8:11], s57 offen offset:1024 sc0 nt lds
  buffer_load_dwordx4 v3, s[8:11], s57 offen offset:2048 sc0 nt lds
  s_add_u32 m0, s58, 25600
  s_add_u32 s57, s56, 70656
  buffer_load_dwordx4 v4, s[8:11], s57 offen offset:0 sc0 nt lds
  buffer_load_dwordx4 v5, s[8:11], s57 offen offset:1024 sc0 nt lds
  buffer_load_dwordx4 v6, s[8:11], s57 offen offset:2048 sc0 nt lds
  s_nop 1
  v_and_b32 v20, 0xffff0000, v88
  v_and_b32 v21, 0xffff0000, v89
  v_and_b32 v22, 0xffff0000, v90
  v_and_b32 v23, 0xffff0000, v91
  v_sub_f32 v24, v88, v20
  v_sub_f32 v25, v89, v21
  v_sub_f32 v26, v90, v22
  v_sub_f32 v27, v91, v23
  v_cndmask_b32 v20, v20, v24, s[90:91]
  v_cndmask_b32 v21, v21, v25, s[90:91]
  v_cndmask_b32 v22, v22, v26, s[90:91]
  v_cndmask_b32 v23, v23, v27, s[90:91]
  v_cvt_pk_bf16_f32 v100, v20, v21
  v_cvt_pk_bf16_f32 v101, v22, v23
  s_waitcnt vmcnt(27)
  ds_read_b128 a[24:27], v14 offset:0
  ds_read_b128 a[28:31], v14 offset:4096
  v_cndmask_b32 v140, v92, v29, s[92:93]
  v_cndmask_b32 v141, v93, v29, s[92:93]
  v_cndmask_b32 v142, v29, v92, s[92:93]
  v_cndmask_b32 v143, v29, v93, s[92:93]
  s_waitcnt lgkmcnt(0)
  s_nop 0
  v_mfma_f32_32x32x16_bf16 v[108:123], a[24:27], v[140:143], 0
  v_mfma_f32_32x32x16_bf16 v[124:139], a[28:31], v[140:143], 0
  ds_read_b128 a[24:27], v15 offset:0
  ds_read_b128 a[28:31], v15 offset:4096
  v_cndmask_b32 v140, v94, v29, s[92:93]
  v_cndmask_b32 v141, v95, v29, s[92:93]
  v_cndmask_b32 v142, v29, v94, s[92:93]
  v_cndmask_b32 v143, v29, v95, s[92:93]
  s_waitcnt lgkmcnt(0)
  s_nop 0
  v_mfma_f32_32x32x16_bf16 v[108:123], a[24:27], v[140:143], v[108:123]
  v_mfma_f32_32x32x16_bf16 v[124:139], a[28:31], v[140:143], v[124:139]
  ds_read_b128 a[24:27], v16 offset:0
  ds_read_b128 a[28:31], v16 offset:4096
  v_cndmask_b32 v140, v96, v29, s[92:93]
  v_cndmask_b32 v141, v97, v29, s[92:93]
  v_cndmask_b32 v142, v29, v96, s[92:93]
  v_cndmask_b32 v143, v29, v97, s[92:93]
  s_waitcnt lgkmcnt(0)
  s_nop 0
  v_mfma_f32_32x32x16_bf16 v[108:123], a[24:27], v[140:143], v[108:123]
  v_mfma_f32_32x32x16_bf16 v[124:139], a[28:31], v[140:143], v[124:139]
  ds_read_b128 a[24:27], v17 offset:0
  ds_read_b128 a[28:31], v17 offset:4096
  v_cndmask_b32 v140, v98, v29, s[92:93]
  v_cndmask_b32 v141, v99, v29, s[92:93]
  v_cndmask_b32 v142, v29, v98, s[92:93]
  v_cndmask_b32 v143, v29, v99, s[92:93]
  s_waitcnt lgkmcnt(0)
  s_nop 0
  v_mfma_f32_32x32x16_bf16 v[108:123], a[24:27], v[140:143], v[108:123]
  v_mfma_f32_32x32x16_bf16 v[124:139], a[28:31], v[140:143], v[124:139]
  s_add_u32 m0, s58, 0
  s_add_u32 s57, s59, 0
  buffer_load_dwordx4 v10, s[20:23], s57 offen offset:0 lds
  s_add_u32 s57, s59, 64512
  buffer_load_dwordx4 v11, s[20:23], s57 offen offset:1024 lds
  s_add_u32 s57, s59, 129024
  buffer_load_dwordx4 v10, s[20:23], s57 offen offset:2048 lds
  s_add_u32 s57, s59, 193536
  buffer_load_dwordx4 v11, s[20:23], s57 offen offset:3072 lds
  s_waitcnt vmcnt(25)
  ds_read_b128 v[64:67], v18 offset:12288
  ds_read_b128 v[68:71], v19 offset:12288
  ds_read_b128 v[72:75], v18 offset:12416
  ds_read_b128 v[76:79], v19 offset:12416
  ds_read_b128 v[80:83], v18 offset:12544
  ds_read_b128 v[84:87], v19 offset:12544
  s_waitcnt lgkmcnt(5)
  v_mfma_f32_16x16x32_bf16 v[88:91], v[64:67], a[0:3], 0
  s_waitcnt lgkmcnt(4)
  v_mfma_f32_16x16x32_bf16 v[88:91], v[68:71], a[4:7], v[88:91]
  s_waitcnt lgkmcnt(3)
  v_mfma_f32_16x16x32_bf16 v[88:91], v[72:75], a[8:11], v[88:91]
  s_waitcnt lgkmcnt(2)
  v_mfma_f32_16x16x32_bf16 v[88:91], v[76:79], a[12:15], v[88:91]
  s_waitcnt lgkmcnt(1)
  v_mfma_f32_16x16x32_bf16 v[88:91], v[80:83], a[16:19], v[88:91]
  s_waitcnt lgkmcnt(0)
  v_mfma_f32_16x16x32_bf16 v[88:91], v[84:87], a[20:23], v[88:91]
  s_add_u32 m0, s58, 28672
  s_add_u32 s57, s56, 0
  buffer_load_dwordx4 v7, s[12:15], s57 offen offset:0 sc0 nt lds
  buffer_load_dwordx4 v8, s[12:15], s57 offen offset:1024 sc0 nt lds
  buffer_load_dwordx4 v9, s[12:15], s57 offen offset:2048 sc0 nt lds
  s_add_u32 m0, s58, 31744
  s_add_u32 s57, s56, 3072
  buffer_load_dwordx4 v7, s[12:15], s57 offen offset:0 sc0 nt lds
  buffer_load_dwordx4 v8, s[12:15], s57 offen offset:1024 sc0 nt lds
  buffer_load_dwordx4 v9, s[12:15], s57 offen offset:2048 sc0 nt lds
  s_add_u32 m0, s58, 4096
  s_add_u32 s57, s59, 262144
  buffer_load_dwordx4 v10, s[20:23], s57 offen offset:0 lds
  s_add_u32 s57, s59, 326656
  buffer_load_dwordx4 v11, s[20:23], s57 offen offset:1024 lds
  s_add_u32 s57, s59, 391168
  buffer_load_dwordx4 v10, s[20:23], s57 offen offset:2048 lds
  s_add_u32 s57, s59, 455680
  buffer_load_dwordx4 v11, s[20:23], s57 offen offset:3072 lds
  s_nop 1
  v_and_b32 v20, 0xffff0000, v88
  v_and_b32 v21, 0xffff0000, v89
  v_and_b32 v22, 0xffff0000, v90
  v_and_b32 v23, 0xffff0000, v91
  v_sub_f32 v24, v88, v20
  v_sub_f32 v25, v89, v21
  v_sub_f32 v26, v90, v22
  v_sub_f32 v27, v91, v23
  v_cndmask_b32 v20, v20, v24, s[90:91]
  v_cndmask_b32 v21, v21, v25, s[90:91]
  v_cndmask_b32 v22, v22, v26, s[90:91]
  v_cndmask_b32 v23, v23, v27, s[90:91]
  v_cvt_pk_bf16_f32 v102, v20, v21
  v_cvt_pk_bf16_f32 v103, v22, v23
  s_waitcnt vmcnt(25)
  ds_read_b128 v[64:67], v18 offset:0
  ds_read_b128 v[68:71], v19 offset:0
  ds_read_b128 v[72:75], v18 offset:128
  ds_read_b128 v[76:79], v19 offset:128
  ds_read_b128 v[80:83], v18 offset:256
  ds_read_b128 v[84:87], v19 offset:256
  s_waitcnt lgkmcnt(5)
  v_mfma_f32_16x16x32_bf16 v[88:91], v[64:67], a[0:3], 0
  s_waitcnt lgkmcnt(4)
  v_mfma_f32_16x16x32_bf16 v[88:91], v[68:71], a[4:7], v[88:91]
  s_waitcnt lgkmcnt(3)
  v_mfma_f32_16x16x32_bf16 v[88:91], v[72:75], a[8:11], v[88:91]
  s_waitcnt lgkmcnt(2)
  v_mfma_f32_16x16x32_bf16 v[88:91], v[76:79], a[12:15], v[88:91]
  s_waitcnt lgkmcnt(1)
  v_mfma_f32_16x16x32_bf16 v[88:91], v[80:83], a[16:19], v[88:91]
  s_waitcnt lgkmcnt(0)
  v_mfma_f32_16x16x32_bf16 v[88:91], v[84:87], a[20:23], v[88:91]
  s_add_u32 m0, s58, 16384
  s_add_u32 s57, s56, 6144
  buffer_load_dwordx4 v7, s[12:15], s57 offen offset:0 sc0 nt lds
  buffer_load_dwordx4 v8, s[12:15], s57 offen offset:1024 sc0 nt lds
  buffer_load_dwordx4 v9, s[12:15], s57 offen offset:2048 sc0 nt lds
  s_add_u32 m0, s58, 19456
  s_add_u32 s57, s56, 9216
  buffer_load_dwordx4 v7, s[12:15], s57 offen offset:0 sc0 nt lds
  buffer_load_dwordx4 v8, s[12:15], s57 offen offset:1024 sc0 nt lds
  buffer_load_dwordx4 v9, s[12:15], s57 offen offset:2048 sc0 nt lds
  s_nop 1
  v_and_b32 v20, 0xffff0000, v88
  v_and_b32 v21, 0xffff0000, v89
  v_and_b32 v22, 0xffff0000, v90
  v_and_b32 v23, 0xffff0000, v91
  v_sub_f32 v24, v88, v20
  v_sub_f32 v25, v89, v21
  v_sub_f32 v26, v90, v22
  v_sub_f32 v27, v91, v23
  v_cndmask_b32 v20, v20, v24, s[90:91]
  v_cndmask_b32 v21, v21, v25, s[90:91]
  v_cndmask_b32 v22, v22, v26, s[90:91]
  v_cndmask_b32 v23, v23, v27, s[90:91]
  v_cvt_pk_bf16_f32 v104, v20, v21
  v_cvt_pk_bf16_f32 v105, v22, v23
  s_waitcnt vmcnt(20)
  ds_read_b128 v[64:67], v18 offset:6144
  ds_read_b128 v[68:71], v19 offset:6144
  ds_read_b128 v[72:75], v18 offset:6272
  ds_read_b128 v[76:79], v19 offset:6272
  ds_read_b128 v[80:83], v18 offset:6400
  ds_read_b128 v[84:87], v19 offset:6400
  s_waitcnt lgkmcnt(5)
  v_mfma_f32_16x16x32_bf16 v[88:91], v[64:67], a[0:3], 0
  s_waitcnt lgkmcnt(4)
  v_mfma_f32_16x16x32_bf16 v[88:91], v[68:71], a[4:7], v[88:91]
  s_waitcnt lgkmcnt(3)
  v_mfma_f32_16x16x32_bf16 v[88:91], v[72:75], a[8:11], v[88:91]
  s_waitcnt lgkmcnt(2)
  v_mfma_f32_16x16x32_bf16 v[88:91], v[76:79], a[12:15], v[88:91]
  s_waitcnt lgkmcnt(1)
  v_mfma_f32_16x16x32_bf16 v[88:91], v[80:83], a[16:19], v[88:91]
  s_waitcnt lgkmcnt(0)
  v_mfma_f32_16x16x32_bf16 v[88:91], v[84:87], a[20:23], v[88:91]
  s_add_u32 m0, s58, 22528
  s_add_u32 s57, s56, 12288
  buffer_load_dwordx4 v7, s[12:15], s57 offen offset:0 sc0 nt lds
  buffer_load_dwordx4 v8, s[12:15], s57 offen offset:1024 sc0 nt lds
  buffer_load_dwordx4 v9, s[12:15], s57 offen offset:2048 sc0 nt lds
  s_add_u32 m0, s58, 25600
  s_add_u32 s57, s56, 15360
  buffer_load_dwordx4 v7, s[12:15], s57 offen offset:0 sc0 nt lds
  buffer_load_dwordx4 v8, s[12:15], s57 offen offset:1024 sc0 nt lds
  buffer_load_dwordx4 v9, s[12:15], s57 offen offset:2048 sc0 nt lds
  s_nop 1
  v_and_b32 v20, 0xffff0000, v88
  v_and_b32 v21, 0xffff0000, v89
  v_and_b32 v22, 0xffff0000, v90
  v_and_b32 v23, 0xffff0000, v91
  v_sub_f32 v24, v88, v20
  v_sub_f32 v25, v89, v21
  v_sub_f32 v26, v90, v22
  v_sub_f32 v27, v91, v23
  v_cndmask_b32 v20, v20, v24, s[90:91]
  v_cndmask_b32 v21, v21, v25, s[90:91]
  v_cndmask_b32 v22, v22, v26, s[90:91]
  v_cndmask_b32 v23, v23, v27, s[90:91]
  v_cvt_pk_bf16_f32 v106, v20, v21
  v_cvt_pk_bf16_f32 v107, v22, v23
  s_waitcnt vmcnt(33)
  ds_read_b128 a[24:27], v14 offset:8192
  ds_read_b128 a[28:31], v14 offset:12288
  v_cndmask_b32 v140, v100, v29, s[92:93]
  v_cndmask_b32 v141, v101, v29, s[92:93]
  v_cndmask_b32 v142, v29, v100, s[92:93]
  v_cndmask_b32 v143, v29, v101, s[92:93]
  s_waitcnt lgkmcnt(0)
  s_nop 0
  v_mfma_f32_32x32x16_bf16 v[108:123], a[24:27], v[140:143], v[108:123]
  v_mfma_f32_32x32x16_bf16 v[124:139], a[28:31], v[140:143], v[124:139]
  ds_read_b128 a[24:27], v15 offset:8192
  ds_read_b128 a[28:31], v15 offset:12288
  v_cndmask_b32 v140, v102, v29, s[92:93]
  v_cndmask_b32 v141, v103, v29, s[92:93]
  v_cndmask_b32 v142, v29, v102, s[92:93]
  v_cndmask_b32 v143, v29, v103, s[92:93]
  s_waitcnt lgkmcnt(0)
  s_nop 0
  v_mfma_f32_32x32x16_bf16 v[108:123], a[24:27], v[140:143], v[108:123]
  v_mfma_f32_32x32x16_bf16 v[124:139], a[28:31], v[140:143], v[124:139]
  ds_read_b128 a[24:27], v16 offset:8192
  ds_read_b128 a[28:31], v16 offset:12288
  v_cndmask_b32 v140, v104, v29, s[92:93]
  v_cndmask_b32 v141, v105, v29, s[92:93]
  v_cndmask_b32 v142, v29, v104, s[92:93]
  v_cndmask_b32 v143, v29, v105, s[92:93]
  s_waitcnt lgkmcnt(0)
  s_nop 0
  v_mfma_f32_32x32x16_bf16 v[108:123], a[24:27], v[140:143], v[108:123]
  v_mfma_f32_32x32x16_bf16 v[124:139], a[28:31], v[140:143], v[124:139]
  ds_read_b128 a[24:27], v17 offset:8192
  ds_read_b128 a[28:31], v17 offset:12288
  v_cndmask_b32 v140, v106, v29, s[92:93]
  v_cndmask_b32 v141, v107, v29, s[92:93]
  v_cndmask_b32 v142, v29, v106, s[92:93]
  v_cndmask_b32 v143, v29, v107, s[92:93]
  s_waitcnt lgkmcnt(0)
  s_nop 0
  v_mfma_f32_32x32x16_bf16 v[108:123], a[24:27], v[140:143], v[108:123]
  v_mfma_f32_32x32x16_bf16 v[124:139], a[28:31], v[140:143], v[124:139]
  s_nop 15
  v_permlane16_swap_b32 v108, v124
  v_permlane16_swap_b32 v109, v125
  v_permlane16_swap_b32 v110, v126
  v_permlane16_swap_b32 v111, v127
  v_permlane16_swap_b32 v112, v128
  v_permlane16_swap_b32 v113, v129
  v_permlane16_swap_b32 v114, v130
  v_permlane16_swap_b32 v115, v131
  v_permlane16_swap_b32 v116, v132
  v_permlane16_swap_b32 v117, v133
  v_permlane16_swap_b32 v118, v134
  v_permlane16_swap_b32 v119, v135
  v_permlane16_swap_b32 v120, v136
  v_permlane16_swap_b32 v121, v137
  v_permlane16_swap_b32 v122, v138
  v_permlane16_swap_b32 v123, v139
  v_add_f32 v108, v108, v124
  v_add_f32 v109, v109, v125
  v_add_f32 v110, v110, v126
  v_add_f32 v111, v111, v127
  v_add_f32 v112, v112, v128
  v_add_f32 v113, v113, v129
  v_add_f32 v114, v114, v130
  v_add_f32 v115, v115, v131
  v_add_f32 v116, v116, v132
  v_add_f32 v117, v117, v133
  v_add_f32 v118, v118, v134
  v_add_f32 v119, v119, v135
  v_add_f32 v120, v120, v136
  v_add_f32 v121, v121, v137
  v_add_f32 v122, v122, v138
  v_add_f32 v123, v123, v139
  s_nop 1
  v_add_f32_dpp v108, v108, v108 quad_perm:[1,0,3,2] row_mask:0xf bank_mask:0xf
  v_add_f32_dpp v109, v109, v109 quad_perm:[1,0,3,2] row_mask:0xf bank_mask:0xf
  v_add_f32_dpp v110, v110, v110 quad_perm:[1,0,3,2] row_mask:0xf bank_mask:0xf
  v_add_f32_dpp v111, v111, v111 quad_perm:[1,0,3,2] row_mask:0xf bank_mask:0xf
  v_add_f32_dpp v112, v112, v112 quad_perm:[1,0,3,2] row_mask:0xf bank_mask:0xf
  v_add_f32_dpp v113, v113, v113 quad_perm:[1,0,3,2] row_mask:0xf bank_mask:0xf
  v_add_f32_dpp v114, v114, v114 quad_perm:[1,0,3,2] row_mask:0xf bank_mask:0xf
  v_add_f32_dpp v115, v115, v115 quad_perm:[1,0,3,2] row_mask:0xf bank_mask:0xf
  v_add_f32_dpp v116, v116, v116 quad_perm:[1,0,3,2] row_mask:0xf bank_mask:0xf
  v_add_f32_dpp v117, v117, v117 quad_perm:[1,0,3,2] row_mask:0xf bank_mask:0xf
  v_add_f32_dpp v118, v118, v118 quad_perm:[1,0,3,2] row_mask:0xf bank_mask:0xf
  v_add_f32_dpp v119, v119, v119 quad_perm:[1,0,3,2] row_mask:0xf bank_mask:0xf
  v_add_f32_dpp v120, v120, v120 quad_perm:[1,0,3,2] row_mask:0xf bank_mask:0xf
  v_add_f32_dpp v121, v121, v121 quad_perm:[1,0,3,2] row_mask:0xf bank_mask:0xf
  v_add_f32_dpp v122, v122, v122 quad_perm:[1,0,3,2] row_mask:0xf bank_mask:0xf
  v_add_f32_dpp v123, v123, v123 quad_perm:[1,0,3,2] row_mask:0xf bank_mask:0xf
  v_bfe_u32 v20, v0, 4, 1
  v_lshlrev_b32 v20, 7, v20
  v_lshrrev_b32 v21, 5, v0
  v_lshl_add_u32 v20, v21, 4, v20
  s_lshl_b32 s60, s3, 8
  s_add_u32 s60, s60, 139264
  v_add_u32 v20, s60, v20
  s_mov_b32 exec_lo, 0x00010001
  s_mov_b32 exec_hi, 0x00010001
  ds_write_b128 v20, v[108:111] offset:0
  ds_write_b128 v20, v[112:115] offset:32
  ds_write_b128 v20, v[116:119] offset:64
  ds_write_b128 v20, v[120:123] offset:96
  s_mov_b64 exec, 1
  v_mov_b32 v20, 147456
  v_mov_b32 v21, 1
  ds_add_rtn_u32 v21, v20, v21
  s_mov_b64 exec, -1
  s_waitcnt vmcnt(32)
  v_readfirstlane_b32 s65, v31
  s_mov_b32 s66, 0
L_nn:
  s_cmp_lg_u32 s65, 0
  s_cbranch_scc1 L_nok
  s_add_u32 s66, s66, 1
  s_cmp_ge_u32 s66, 20000
  s_cbranch_scc1 L_nok
  s_lshl_b32 s60, s62, 2
  s_add_u32 s60, s60, 128
  v_mov_b32 v22, 0
  buffer_load_dword v31, v22, s[48:51], s60 offen sc1
  s_waitcnt vmcnt(0)
  v_readfirstlane_b32 s65, v31
  s_branch L_nn
L_nok:
  s_waitcnt lgkmcnt(0)
  v_readfirstlane_b32 s60, v21
  s_cmp_eq_u32 s60, 3
  s_cbranch_scc0 L_pub1
  v_lshlrev_b32 v20, 2, v0
  v_add_u32 v20, 139264, v20
  ds_read_b32 v32, v20 offset:0
  ds_read_b32 v33, v20 offset:256
  ds_read_b32 v34, v20 offset:512
  ds_read_b32 v35, v20 offset:768
  s_waitcnt lgkmcnt(0)
  v_add_f32 v32, v32, v33
  v_add_f32 v34, v34, v35
  v_add_f32 v32, v32, v34
  v_mov_b32 v33, s65
  v_lshlrev_b32 v22, 3, v0
  buffer_store_dwordx2 v[32:33], v22, s[40:43], s63 offen sc1
L_pub1:
  s_add_u32 m0, s58, 8192
  s_add_u32 s57, s59, 256
  buffer_load_dwordx4 v10, s[20:23], s57 offen offset:0 lds
  s_add_u32 s57, s59, 64768
  buffer_load_dwordx4 v11, s[20:23], s57 offen offset:1024 lds
  s_add_u32 s57, s59, 129280
  buffer_load_dwordx4 v10, s[20:23], s57 offen offset:2048 lds
  s_waitcnt vmcnt(15)
  ds_read_b128 a[24:27], v14 offset:0
  ds_read_b128 a[28:31], v14 offset:4096
  ds_read_b64_tr_b16 a[0:1], v12 offset:12288
  ds_read_b64_tr_b16 a[2:3], v12 offset:13824
  ds_read_b64_tr_b16 a[4:5], v13 offset:12352
  ds_read_b64_tr_b16 a[6:7], v13 offset:13888
  ds_read_b64_tr_b16 a[8:9], v12 offset:12416
  ds_read_b64_tr_b16 a[10:11], v12 offset:13952
  ds_read_b64_tr_b16 a[12:13], v13 offset:12480
  ds_read_b64_tr_b16 a[14:15], v13 offset:14016
  ds_read_b64_tr_b16 a[16:17], v12 offset:12544
  ds_read_b64_tr_b16 a[18:19], v12 offset:14080
  ds_read_b64_tr_b16 a[20:21], v13 offset:12608
  ds_read_b64_tr_b16 a[22:23], v13 offset:14144
  s_waitcnt lgkmcnt(0)
  s_add_u32 m0, s58, 28672
  s_add_u32 s57, s56, 18432
  buffer_load_dwordx4 v7, s[12:15], s57 offen offset:0 sc0 nt lds
  v_mfma_f32_32x32x16_bf16 v[64:79], a[24:27], a[0:3], 0
  v_mfma_f32_32x32x16_bf16 v[160:175], a[28:31], a[0:3], 0
  s_add_u32 m0, s58, 28672
  s_add_u32 s57, s56, 18432
  buffer_load_dwordx4 v8, s[12:15], s57 offen offset:1024 sc0 nt lds
  v_mfma_f32_32x32x16_bf16 v[80:95], a[24:27], a[4:7], 0
  v_mfma_f32_32x32x16_bf16 v[176:191], a[28:31], a[4:7], 0
  s_add_u32 m0, s58, 28672
  s_add_u32 s57, s56, 18432
  buffer_load_dwordx4 v9, s[12:15], s57 offen offset:2048 sc0 nt lds
  v_mfma_f32_32x32x16_bf16 v[96:111], a[24:27], a[8:11], 0
  v_mfma_f32_32x32x16_bf16 v[192:207], a[28:31], a[8:11], 0
  s_add_u32 m0, s58, 31744
  s_add_u32 s57, s56, 21504
  buffer_load_dwordx4 v7, s[12:15], s57 offen offset:0 sc0 nt lds
  v_mfma_f32_32x32x16_bf16 v[112:127], a[24:27], a[12:15], 0
  v_mfma_f32_32x32x16_bf16 v[208:223], a[28:31], a[12:15], 0
  s_add_u32 m0, s58, 31744
  s_add_u32 s57, s56, 21504
  buffer_load_dwordx4 v8, s[12:15], s57 offen offset:1024 sc0 nt lds
  v_mfma_f32_32x32x16_bf16 v[128:143], a[24:27], a[16:19], 0
  v_mfma_f32_32x32x16_bf16 v[224:239], a[28:31], a[16:19], 0
  s_add_u32 m0, s58, 31744
  s_add_u32 s57, s56, 21504
  buffer_load_dwordx4 v9, s[12:15], s57 offen offset:2048 sc0 nt lds
  v_mfma_f32_32x32x16_bf16 v[144:159], a[24:27], a[20:23], 0
  v_mfma_f32_32x32x16_bf16 v[240:255], a[28:31], a[20:23], 0
  s_add_u32 m0, s58, 8192
  s_add_u32 s57, s59, 193792
  buffer_load_dwordx4 v11, s[20:23], s57 offen offset:3072 lds
  s_add_u32 m0, s58, 12288
  s_add_u32 s57, s59, 262400
  buffer_load_dwordx4 v10, s[20:23], s57 offen offset:0 lds
  s_add_u32 s57, s59, 326912
  buffer_load_dwordx4 v11, s[20:23], s57 offen offset:1024 lds
  s_waitcnt vmcnt(18)
  ds_read_b128 a[24:27], v15 offset:0
  ds_read_b128 a[28:31], v15 offset:4096
  ds_read_b64_tr_b16 a[0:1], v12 offset:0
  ds_read_b64_tr_b16 a[2:3], v12 offset:1536
  ds_read_b64_tr_b16 a[4:5], v13 offset:64
  ds_read_b64_tr_b16 a[6:7], v13 offset:1600
  ds_read_b64_tr_b16 a[8:9], v12 offset:128
  ds_read_b64_tr_b16 a[10:11], v12 offset:1664
  ds_read_b64_tr_b16 a[12:13], v13 offset:192
  ds_read_b64_tr_b16 a[14:15], v13 offset:1728
  ds_read_b64_tr_b16 a[16:17], v12 offset:256
  ds_read_b64_tr_b16 a[18:19], v12 offset:1792
  ds_read_b64_tr_b16 a[20:21], v13 offset:320
  ds_read_b64_tr_b16 a[22:23], v13 offset:1856
  s_waitcnt lgkmcnt(0)
  s_add_u32 m0, s58, 12288
  s_add_u32 s57, s59, 391424
  buffer_load_dwordx4 v10, s[20:23], s57 offen offset:2048 lds
  s_add_u32 s57, s59, 455936
  buffer_load_dwordx4 v11, s[20:23], s57 offen offset:3072 lds
  s_add_u32 m0, s58, 16384
  s_add_u32 s57, s56, 49152
  buffer_load_dwordx4 v7, s[12:15], s57 offen offset:0 sc0 nt lds
  v_mfma_f32_32x32x16_bf16 v[64:79], a[24:27], a[0:3], v[64:79]
  v_mfma_f32_32x32x16_bf16 v[160:175], a[28:31], a[0:3], v[160:175]
  s_add_u32 m0, s58, 16384
  s_add_u32 s57, s56, 49152
  buffer_load_dwordx4 v8, s[12:15], s57 offen offset:1024 sc0 nt lds
  v_mfma_f32_32x32x16_bf16 v[80:95], a[24:27], a[4:7], v[80:95]
  v_mfma_f32_32x32x16_bf16 v[176:191], a[28:31], a[4:7], v[176:191]
  s_add_u32 m0, s58, 16384
  s_add_u32 s57, s56, 49152
  buffer_load_dwordx4 v9, s[12:15], s57 offen offset:2048 sc0 nt lds
  v_mfma_f32_32x32x16_bf16 v[96:111], a[24:27], a[8:11], v[96:111]
  v_mfma_f32_32x32x16_bf16 v[192:207], a[28:31], a[8:11], v[192:207]
  s_add_u32 m0, s58, 19456
  s_add_u32 s57, s56, 52224
  buffer_load_dwordx4 v7, s[12:15], s57 offen offset:0 sc0 nt lds
  v_mfma_f32_32x32x16_bf16 v[112:127], a[24:27], a[12:15], v[112:127]
  v_mfma_f32_32x32x16_bf16 v[208:223], a[28:31], a[12:15], v[208:223]
  s_add_u32 m0, s58, 19456
  s_add_u32 s57, s56, 52224
  buffer_load_dwordx4 v8, s[12:15], s57 offen offset:1024 sc0 nt lds
  v_mfma_f32_32x32x16_bf16 v[128:143], a[24:27], a[16:19], v[128:143]
  v_mfma_f32_32x32x16_bf16 v[224:239], a[28:31], a[16:19], v[224:239]
  s_add_u32 m0, s58, 19456
  s_add_u32 s57, s56, 52224
  buffer_load_dwordx4 v9, s[12:15], s57 offen offset:2048 sc0 nt lds
  v_mfma_f32_32x32x16_bf16 v[144:159], a[24:27], a[20:23], v[144:159]
  v_mfma_f32_32x32x16_bf16 v[240:255], a[28:31], a[20:23], v[240:255]
  s_barrier
  s_waitcnt vmcnt(20)
  ds_read_b128 a[24:27], v16 offset:0
  ds_read_b128 a[28:31], v16 offset:4096
  ds_read_b64_tr_b16 a[0:1], v12 offset:6144
  ds_read_b64_tr_b16 a[2:3], v12 offset:7680
  ds_read_b64_tr_b16 a[4:5], v13 offset:6208
  ds_read_b64_tr_b16 a[6:7], v13 offset:7744
  ds_read_b64_tr_b16 a[8:9], v12 offset:6272
  ds_read_b64_tr_b16 a[10:11], v12 offset:7808
  ds_read_b64_tr_b16 a[12:13], v13 offset:6336
  ds_read_b64_tr_b16 a[14:15], v13 offset:7872
  ds_read_b64_tr_b16 a[16:17], v12 offset:6400
  ds_read_b64_tr_b16 a[18:19], v12 offset:7936
  ds_read_b64_tr_b16 a[20:21], v13 offset:6464
  ds_read_b64_tr_b16 a[22:23], v13 offset:8000
  s_lshl_b32 s60, s3, 10
  s_add_u32 s60, s60, 140288
  v_lshrrev_b32 v25, 5, v0
  v_and_b32 v24, 1, v0
  v_lshlrev_b32 v24, 7, v24
  v_add_u32 v10, s60, v24
  v_lshl_add_u32 v24, v25, 4, v24
  v_add_u32 v1, s60, v24
  v_lshl_add_u32 v30, v25, 4, s60
  v_bfe_u32 v26, v0, 2, 2
  v_lshl_add_u32 v26, v25, 3, v26
  v_lshlrev_b32 v26, 7, v26
  v_bfe_u32 v27, v0, 4, 1
  v_bfe_u32 v28, v0, 1, 1
  v_lshl_add_u32 v27, v27, 1, v28
  v_bfe_u32 v28, v0, 3, 1
  v_lshl_add_u32 v28, v25, 2, v28
  v_xor_b32 v27, v27, v28
  v_lshl_add_u32 v26, v27, 4, v26
  v_and_b32 v27, 1, v0
  v_lshl_add_u32 v26, v27, 3, v26
  s_add_u32 s57, s58, 8192
  v_add_u32 v2, s57, v26
  v_xor_b32 v27, 32, v26
  v_add_u32 v3, s57, v27
  v_xor_b32 v27, 64, v26
  v_add_u32 v4, s57, v27
  v_xor_b32 v27, 96, v26
  v_add_u32 v5, s57, v27
  v_and_b32 v26, 31, v0
  v_lshl_add_u32 v26, v26, 1, s60
  v_lshl_add_u32 v6, v25, 7, v26
  v_mul_u32_u24 v26, 384, v25
  v_and_b32 v27, 31, v0
  v_lshl_add_u32 v26, v27, 2, v26
  s_mul_i32 s60, s3, 768
  s_add_u32 s60, s60, 144384
  v_add_u32 v11, s60, v26
  s_waitcnt lgkmcnt(0)
  s_and_b32 s60, s2, 0xf8
  s_lshl_b32 s60, s60, 9
  v_lshlrev_b32 v22, 3, v0
  buffer_load_dwordx2 v[32:33], v22, s[40:43], s60 offen offset:0
  buffer_load_dwordx2 v[34:35], v22, s[40:43], s60 offen offset:512
  buffer_load_dwordx2 v[36:37], v22, s[40:43], s60 offen offset:1024
  buffer_load_dwordx2 v[38:39], v22, s[40:43], s60 offen offset:1536
  buffer_load_dwordx2 v[40:41], v22, s[40:43], s60 offen offset:2048
  buffer_load_dwordx2 v[42:43], v22, s[40:43], s60 offen offset:2560
  buffer_load_dwordx2 v[44:45], v22, s[40:43], s60 offen offset:3072
  buffer_load_dwordx2 v[46:47], v22, s[40:43], s60 offen offset:3584
  s_add_u32 m0, s58, 22528
  s_add_u32 s57, s56, 55296
  buffer_load_dwordx4 v7, s[12:15], s57 offen offset:0 sc0 nt lds
  v_mfma_f32_32x32x16_bf16 v[64:79], a[24:27], a[0:3], v[64:79]
  v_mfma_f32_32x32x16_bf16 v[160:175], a[28:31], a[0:3], v[160:175]
  s_add_u32 m0, s58, 22528
  s_add_u32 s57, s56, 55296
  buffer_load_dwordx4 v8, s[12:15], s57 offen offset:1024 sc0 nt lds
  v_mfma_f32_32x32x16_bf16 v[80:95], a[24:27], a[4:7], v[80:95]
  v_mfma_f32_32x32x16_bf16 v[176:191], a[28:31], a[4:7], v[176:191]
  s_add_u32 m0, s58, 22528
  s_add_u32 s57, s56, 55296
  buffer_load_dwordx4 v9, s[12:15], s57 offen offset:2048 sc0 nt lds
  v_mfma_f32_32x32x16_bf16 v[96:111], a[24:27], a[8:11], v[96:111]
  v_mfma_f32_32x32x16_bf16 v[192:207], a[28:31], a[8:11], v[192:207]
  s_add_u32 m0, s58, 25600
  s_add_u32 s57, s56, 58368
  buffer_load_dwordx4 v7, s[12:15], s57 offen offset:0 sc0 nt lds
  v_mfma_f32_32x32x16_bf16 v[112:127], a[24:27], a[12:15], v[112:127]
  v_mfma_f32_32x32x16_bf16 v[208:223], a[28:31], a[12:15], v[208:223]
  s_add_u32 m0, s58, 25600
  s_add_u32 s57, s56, 58368
  buffer_load_dwordx4 v8, s[12:15], s57 offen offset:1024 sc0 nt lds
  v_mfma_f32_32x32x16_bf16 v[128:143], a[24:27], a[16:19], v[128:143]
  v_mfma_f32_32x32x16_bf16 v[224:239], a[28:31], a[16:19], v[224:239]
  s_add_u32 m0, s58, 25600
  s_add_u32 s57, s56, 58368
  buffer_load_dwordx4 v9, s[12:15], s57 offen offset:2048 sc0 nt lds
  v_mfma_f32_32x32x16_bf16 v[144:159], a[24:27], a[20:23], v[144:159]
  v_mfma_f32_32x32x16_bf16 v[240:255], a[28:31], a[20:23], v[240:255]
  s_waitcnt vmcnt(25)
  ds_read_b128 a[24:27], v17 offset:0
  ds_read_b128 a[28:31], v17 offset:4096
  ds_read_b64_tr_b16 a[0:1], v12 offset:12288
  ds_read_b64_tr_b16 a[2:3], v12 offset:13824
  ds_read_b64_tr_b16 a[4:5], v13 offset:12352
  ds_read_b64_tr_b16 a[6:7], v13 offset:13888
  ds_read_b64_tr_b16 a[8:9], v12 offset:12416
  ds_read_b64_tr_b16 a[10:11], v12 offset:13952
  ds_read_b64_tr_b16 a[12:13], v13 offset:12480
  ds_read_b64_tr_b16 a[14:15], v13 offset:14016
  ds_read_b64_tr_b16 a[16:17], v12 offset:12544
  ds_read_b64_tr_b16 a[18:19], v12 offset:14080
  ds_read_b64_tr_b16 a[20:21], v13 offset:12608
  ds_read_b64_tr_b16 a[22:23], v13 offset:14144
  s_waitcnt lgkmcnt(0)
  s_and_b32 s60, s2, 0xf8
  s_lshl_b32 s60, s60, 9
  v_lshlrev_b32 v22, 3, v0
  buffer_load_dwordx2 a[176:177], v22, s[40:43], s60 offen offset:0 sc1
  buffer_load_dwordx2 a[178:179], v22, s[40:43], s60 offen offset:512 sc1
  buffer_load_dwordx2 a[180:181], v22, s[40:43], s60 offen offset:1024 sc1
  buffer_load_dwordx2 a[182:183], v22, s[40:43], s60 offen offset:1536 sc1
  buffer_load_dwordx2 a[184:185], v22, s[40:43], s60 offen offset:2048 sc1
  buffer_load_dwordx2 a[186:187], v22, s[40:43], s60 offen offset:2560 sc1
  buffer_load_dwordx2 a[188:189], v22, s[40:43], s60 offen offset:3072 sc1
  buffer_load_dwordx2 a[190:191], v22, s[40:43], s60 offen offset:3584 sc1
  s_add_u32 m0, s58, 28672
  s_add_u32 s57, s56, 61440
  buffer_load_dwordx4 v7, s[12:15], s57 offen offset:0 sc0 nt lds
  v_mfma_f32_32x32x16_bf16 v[64:79], a[24:27], a[0:3], v[64:79]
  v_mfma_f32_32x32x16_bf16 v[160:175], a[28:31], a[0:3], v[160:175]
  s_add_u32 m0, s58, 28672
  s_add_u32 s57, s56, 61440
  buffer_load_dwordx4 v8, s[12:15], s57 offen offset:1024 sc0 nt lds
  v_mfma_f32_32x32x16_bf16 v[80:95], a[24:27], a[4:7], v[80:95]
  v_mfma_f32_32x32x16_bf16 v[176:191], a[28:31], a[4:7], v[176:191]
  s_add_u32 m0, s58, 28672
  s_add_u32 s57, s56, 61440
  buffer_load_dwordx4 v9, s[12:15], s57 offen offset:2048 sc0 nt lds
  v_mfma_f32_32x32x16_bf16 v[96:111], a[24:27], a[8:11], v[96:111]
  v_mfma_f32_32x32x16_bf16 v[192:207], a[28:31], a[8:11], v[192:207]
  s_add_u32 m0, s58, 31744
  s_add_u32 s57, s56, 64512
  buffer_load_dwordx4 v7, s[12:15], s57 offen offset:0 sc0 nt lds
  v_mfma_f32_32x32x16_bf16 v[112:127], a[24:27], a[12:15], v[112:127]
  v_mfma_f32_32x32x16_bf16 v[208:223], a[28:31], a[12:15], v[208:223]
  s_add_u32 m0, s58, 31744
  s_add_u32 s57, s56, 64512
  buffer_load_dwordx4 v8, s[12:15], s57 offen offset:1024 sc0 nt lds
  v_mfma_f32_32x32x16_bf16 v[128:143], a[24:27], a[16:19], v[128:143]
  v_mfma_f32_32x32x16_bf16 v[224:239], a[28:31], a[16:19], v[224:239]
  s_add_u32 m0, s58, 31744
  s_add_u32 s57, s56, 64512
  buffer_load_dwordx4 v9, s[12:15], s57 offen offset:2048 sc0 nt lds
  v_mfma_f32_32x32x16_bf16 v[144:159], a[24:27], a[20:23], v[144:159]
  v_mfma_f32_32x32x16_bf16 v[240:255], a[28:31], a[20:23], v[240:255]
  s_waitcnt vmcnt(20)
  ds_read_b128 a[24:27], v14 offset:8192
  ds_read_b128 a[28:31], v14 offset:12288
  ds_read_b64_tr_b16 a[0:1], v12 offset:0
  ds_read_b64_tr_b16 a[2:3], v12 offset:1536
  ds_read_b64_tr_b16 a[4:5], v13 offset:64
  ds_read_b64_tr_b16 a[6:7], v13 offset:1600
  ds_read_b64_tr_b16 a[8:9], v12 offset:128
  ds_read_b64_tr_b16 a[10:11], v12 offset:1664
  ds_read_b64_tr_b16 a[12:13], v13 offset:192
  ds_read_b64_tr_b16 a[14:15], v13 offset:1728
  ds_read_b64_tr_b16 a[16:17], v12 offset:256
  ds_read_b64_tr_b16 a[18:19], v12 offset:1792
  ds_read_b64_tr_b16 a[20:21], v13 offset:320
  ds_read_b64_tr_b16 a[22:23], v13 offset:1856
  s_movk_i32 s60, -2880
  v_mov_b32 v21, s60
  v_cndmask_b32 v20, v12, v13, s[94:95]
  v_cndmask_b32 v22, v13, v12, s[94:95]
  v_cndmask_b32 v21, 0, v21, s[94:95]
  v_add_u32 v12, v20, v21
  v_add_u32 v13, v22, v21
  v_cmp_ne_u32 vcc, s65, v33
  v_cmp_ne_u32 s[68:69], s65, v35
  s_or_b64 vcc, vcc, s[68:69]
  v_cmp_ne_u32 s[68:69], s65, v37
  s_or_b64 vcc, vcc, s[68:69]
  v_cmp_ne_u32 s[68:69], s65, v39
  s_or_b64 vcc, vcc, s[68:69]
  v_cmp_ne_u32 s[68:69], s65, v41
  s_or_b64 vcc, vcc, s[68:69]
  v_cmp_ne_u32 s[68:69], s65, v43
  s_or_b64 vcc, vcc, s[68:69]
  v_cmp_ne_u32 s[68:69], s65, v45
  s_or_b64 vcc, vcc, s[68:69]
  v_cmp_ne_u32 s[68:69], s65, v47
  s_or_b64 vcc, vcc, s[68:69]
  s_waitcnt lgkmcnt(0)
  s_cmp_eq_u64 vcc, 0
  s_cbranch_scc0 L_pslow
  s_add_u32 m0, s58, 16384
  s_add_u32 s57, s56, 67584
  buffer_load_dwordx4 v7, s[12:15], s57 offen offset:0 sc0 nt lds
  ds_read_b64_tr_b16 a[48:49], v2 offset:0
  ds_read_b64_tr_b16 a[50:51], v3 offset:512
  ds_read_b64_tr_b16 a[64:65], v4 offset:0
  ds_read_b64_tr_b16 a[66:67], v5 offset:512
  ds_read_b64_tr_b16 a[52:53], v2 offset:2048
  ds_read_b64_tr_b16 a[54:55], v3 offset:2560
  ds_read_b64_tr_b16 a[68:69], v4 offset:2048
  ds_read_b64_tr_b16 a[70:71], v5 offset:2560
  ds_read_b64_tr_b16 a[56:57], v2 offset:4096
  ds_read_b64_tr_b16 a[58:59], v3 offset:4608
  ds_read_b64_tr_b16 a[72:73], v4 offset:4096
  ds_read_b64_tr_b16 a[74:75], v5 offset:4608
  ds_read_b64_tr_b16 a[60:61], v2 offset:6144
  ds_read_b64_tr_b16 a[62:63], v3 offset:6656
  ds_read_b64_tr_b16 a[76:77], v4 offset:6144
  ds_read_b64_tr_b16 a[78:79], v5 offset:6656
  s_add_u32 m0, s58, 16384
  s_add_u32 s57, s56, 67584
  buffer_load_dwordx4 v8, s[12:15], s57 offen offset:1024 sc0 nt lds
  v_add_f32 v20, v32, v34
  v_add_f32 v21, v36, v38
  v_add_f32 v22, v40, v42
  v_add_f32 v23, v44, v46
  v_add_f32 v20, v20, v21
  v_mfma_f32_32x32x16_bf16 v[64:79], a[24:27], a[0:3], v[64:79]
  v_add_f32 v22, v22, v23
  v_add_f32 v20, v20, v22
  v_mul_f32 v20, 0x3dd53b95, v20
  v_mov_b32 v21, v20
  v_mfma_f32_32x32x16_bf16 v[160:175], a[28:31], a[0:3], v[160:175]
  s_nop 1
  v_max_f32_dpp v21, v21, v21 row_ror:8 row_mask:0xf bank_mask:0xf
  s_nop 1
  v_max_f32_dpp v21, v21, v21 row_ror:4 row_mask:0xf bank_mask:0xf
  v_mfma_f32_32x32x16_bf16 v[80:95], a[24:27], a[4:7], v[80:95]
  s_nop 1
  v_max_f32_dpp v21, v21, v21 row_ror:2 row_mask:0xf bank_mask:0xf
  s_nop 1
  v_max_f32_dpp v21, v21, v21 row_ror:1 row_mask:0xf bank_mask:0xf
  s_add_u32 m0, s58, 16384
  s_add_u32 s57, s56, 67584
  buffer_load_dwordx4 v9, s[12:15], s57 offen offset:2048 sc0 nt lds
  v_mfma_f32_32x32x16_bf16 v[176:191], a[28:31], a[4:7], v[176:191]
  v_mov_b32 v16, v21
  s_nop 1
  v_permlane16_swap_b32 v21, v16
  v_max_f32 v21, v21, v16
  v_mfma_f32_32x32x16_bf16 v[96:111], a[24:27], a[8:11], v[96:111]
  v_mov_b32 v16, v21
  s_nop 1
  v_permlane32_swap_b32 v21, v16
  v_max_f32 v21, v21, v16
  v_mfma_f32_32x32x16_bf16 v[192:207], a[28:31], a[8:11], v[192:207]
  v_sub_f32 v20, v20, v21
  v_exp_f32 v20, v20
  s_lshl_b32 s60, s3, 10
  s_add_u32 s60, s60, 140288
  v_mfma_f32_32x32x16_bf16 v[112:127], a[24:27], a[12:15], v[112:127]
  v_lshl_add_u32 v22, v0, 2, s60
  ds_write_b32 v22, v20
  v_and_b32 v23, 0xffff0000, v20
  v_sub_f32 v23, v20, v23
  s_add_u32 m0, s58, 19456
  s_add_u32 s57, s56, 70656
  buffer_load_dwordx4 v7, s[12:15], s57 offen offset:0 sc0 nt lds
  v_mfma_f32_32x32x16_bf16 v[208:223], a[28:31], a[12:15], v[208:223]
  v_lshl_add_u32 v21, v0, 1, s60
  v_cvt_pk_bf16_f32 v23, v23, v23
  ds_write_b16_d16_hi v21, v20 offset:256
  ds_write_b16 v21, v23 offset:384
  v_mfma_f32_32x32x16_bf16 v[128:143], a[24:27], a[16:19], v[128:143]
  ds_read_b128 a[32:35], v1 offset:256
  ds_read_b128 a[36:39], v1 offset:288
  ds_read_b128 a[40:43], v1 offset:320
  ds_read_b128 a[44:47], v1 offset:352
  v_mfma_f32_32x32x16_bf16 v[224:239], a[28:31], a[16:19], v[224:239]
  ds_read_b128 v[32:35], v30 offset:0
  ds_read_b128 v[36:39], v30 offset:32
  ds_read_b128 v[40:43], v30 offset:64
  ds_read_b128 v[44:47], v30 offset:96
  v_mfma_f32_32x32x16_bf16 v[144:159], a[24:27], a[20:23], v[144:159]
  ds_read_b128 v[48:51], v30 offset:128
  ds_read_b128 v[52:55], v30 offset:160
  ds_read_b128 v[56:59], v30 offset:192
  ds_read_b128 v[60:63], v30 offset:224
  v_mfma_f32_32x32x16_bf16 v[240:255], a[28:31], a[20:23], v[240:255]
  s_waitcnt lgkmcnt(11)
  s_add_u32 m0, s58, 19456
  s_add_u32 s57, s56, 70656
  buffer_load_dwordx4 v8, s[12:15], s57 offen offset:1024 sc0 nt lds
  v_mfma_f32_32x32x16_bf16 a[80:95], a[32:35], a[48:51], 0
  v_mov_b32 v21, v20
  s_nop 1
  v_add_f32_dpp v21, v21, v21 row_ror:8 row_mask:0xf bank_mask:0xf
  s_nop 1
  v_mfma_f32_32x32x16_bf16 a[96:111], a[32:35], a[64:67], 0
  v_add_f32_dpp v21, v21, v21 row_ror:4 row_mask:0xf bank_mask:0xf
  s_nop 1
  v_add_f32_dpp v21, v21, v21 row_ror:2 row_mask:0xf bank_mask:0xf
  s_nop 1
  s_waitcnt lgkmcnt(10)
  v_mfma_f32_32x32x16_bf16 a[80:95], a[36:39], a[52:55], a[80:95]
  v_add_f32_dpp v21, v21, v21 row_ror:1 row_mask:0xf bank_mask:0xf
  v_mov_b32 v16, v21
  s_nop 1
  v_permlane16_swap_b32 v21, v16
  v_mfma_f32_32x32x16_bf16 a[96:111], a[36:39], a[68:71], a[96:111]
  v_add_f32 v21, v21, v16
  v_mov_b32 v16, v21
  s_nop 1
  v_permlane32_swap_b32 v21, v16
  s_waitcnt lgkmcnt(9)
  s_add_u32 m0, s58, 19456
  s_add_u32 s57, s56, 70656
  buffer_load_dwordx4 v9, s[12:15], s57 offen offset:2048 sc0 nt lds
L_pjoin:
  v_mfma_f32_32x32x16_bf16 a[80:95], a[40:43], a[56:59], a[80:95]
  v_add_f32 v21, v21, v16
  v_rcp_f32 v31, v21
  v_mfma_f32_32x32x16_bf16 a[96:111], a[40:43], a[72:75], a[96:111]
  s_waitcnt lgkmcnt(8)
  v_mfma_f32_32x32x16_bf16 a[80:95], a[44:47], a[60:63], a[80:95]
  v_mfma_f32_32x32x16_bf16 a[96:111], a[44:47], a[76:79], a[96:111]
  s_waitcnt lgkmcnt(0)
  v_pk_mul_f32 v[18:19], v[64:65], v[32:33]
  v_pk_mul_f32 v[20:21], v[80:81], v[32:33]
  v_pk_mul_f32 v[22:23], v[96:97], v[32:33]
  v_pk_mul_f32 v[24:25], v[112:113], v[32:33]
  v_pk_mul_f32 v[26:27], v[128:129], v[32:33]
  v_pk_mul_f32 v[28:29], v[144:145], v[32:33]
  v_pk_fma_f32 v[18:19], v[66:67], v[34:35], v[18:19]
  v_pk_fma_f32 v[20:21], v[82:83], v[34:35], v[20:21]
  v_pk_fma_f32 v[22:23], v[98:99], v[34:35], v[22:23]
  v_pk_fma_f32 v[24:25], v[114:115], v[34:35], v[24:25]
  v_pk_fma_f32 v[26:27], v[130:131], v[34:35], v[26:27]
  v_pk_fma_f32 v[28:29], v[146:147], v[34:35], v[28:29]
  v_accvgpr_read_b32 v14, a80
  v_accvgpr_read_b32 v15, a81
  v_pk_fma_f32 v[18:19], v[68:69], v[36:37], v[18:19]
  v_add_f32 v14, v14, v15
  v_mul_f32 v14, v14, v31
  v_and_b32 v15, 0xffff0000, v14
  v_sub_f32 v15, v14, v15
  v_lshrrev_b32 v14, 16, v14
  v_cvt_pk_bf16_f32 v15, v15, v15
  v_cndmask_b32 v14, v14, v15, s[94:95]
  ds_write_b16 v6, v14 offset:512
  v_accvgpr_read_b32 v14, a96
  v_accvgpr_read_b32 v15, a97
  v_pk_fma_f32 v[20:21], v[84:85], v[36:37], v[20:21]
  v_add_f32 v14, v14, v15
  v_mul_f32 v14, v14, v31
  v_and_b32 v15, 0xffff0000, v14
  v_sub_f32 v15, v14, v15
  v_lshrrev_b32 v14, 16, v14
  v_cvt_pk_bf16_f32 v15, v15, v15
  v_cndmask_b32 v14, v14, v15, s[94:95]
  ds_write_b16 v6, v14 offset:576
  ds_read_b128 a[136:139], v10 offset:544
  ds_read_b128 a[140:143], v10 offset:560
  ds_read_b128 a[144:147], v10 offset:576
  ds_read_b128 a[148:151], v10 offset:592
  ds_read_b128 a[152:155], v10 offset:608
  ds_read_b128 a[156:159], v10 offset:624
  v_pk_fma_f32 v[22:23], v[100:101], v[36:37], v[22:23]
  v_pk_fma_f32 v[24:25], v[116:117], v[36:37], v[24:25]
  v_pk_fma_f32 v[26:27], v[132:133], v[36:37], v[26:27]
  v_pk_fma_f32 v[28:29], v[148:149], v[36:37], v[28:29]
  v_pk_fma_f32 v[18:19], v[70:71], v[38:39], v[18:19]
  v_pk_fma_f32 v[20:21], v[86:87], v[38:39], v[20:21]
  v_pk_fma_f32 v[22:23], v[102:103], v[38:39], v[22:23]
  v_pk_fma_f32 v[24:25], v[118:119], v[38:39], v[24:25]
  v_pk_fma_f32 v[26:27], v[134:135], v[38:39], v[26:27]
  v_pk_fma_f32 v[28:29], v[150:151], v[38:39], v[28:29]
  v_pk_fma_f32 v[18:19], v[72:73], v[40:41], v[18:19]
  v_pk_fma_f32 v[20:21], v[88:89], v[40:41], v[20:21]
  v_pk_fma_f32 v[22:23], v[104:105], v[40:41], v[22:23]
  v_pk_fma_f32 v[24:25], v[120:121], v[40:41], v[24:25]
  v_pk_fma_f32 v[26:27], v[136:137], v[40:41], v[26:27]
  v_pk_fma_f32 v[28:29], v[152:153], v[40:41], v[28:29]
  v_pk_fma_f32 v[18:19], v[74:75], v[42:43], v[18:19]
  v_pk_fma_f32 v[20:21], v[90:91], v[42:43], v[20:21]
  v_pk_fma_f32 v[22:23], v[106:107], v[42:43], v[22:23]
  v_pk_fma_f32 v[24:25], v[122:123], v[42:43], v[24:25]
  v_pk_fma_f32 v[26:27], v[138:139], v[42:43], v[26:27]
  v_pk_fma_f32 v[28:29], v[154:155], v[42:43], v[28:29]
  v_pk_fma_f32 v[18:19], v[76:77], v[44:45], v[18:19]
  v_pk_fma_f32 v[20:21], v[92:93], v[44:45], v[20:21]
  v_pk_fma_f32 v[22:23], v[108:109], v[44:45], v[22:23]
  v_pk_fma_f32 v[24:25], v[124:125], v[44:45], v[24:25]
  v_pk_fma_f32 v[26:27], v[140:141], v[44:45], v[26:27]
  v_pk_fma_f32 v[28:29], v[156:157], v[44:45], v[28:29]
  v_pk_fma_f32 v[18:19], v[78:79], v[46:47], v[18:19]
  v_pk_fma_f32 v[20:21], v[94:95], v[46:47], v[20:21]
  v_pk_fma_f32 v[22:23], v[110:111], v[46:47], v[22:23]
  v_pk_fma_f32 v[24:25], v[126:127], v[46:47], v[24:25]
  v_pk_fma_f32 v[26:27], v[142:143], v[46:47], v[26:27]
  v_pk_fma_f32 v[28:29], v[158:159], v[46:47], v[28:29]
  v_pk_fma_f32 v[18:19], v[160:161], v[48:49], v[18:19]
  v_pk_fma_f32 v[20:21], v[176:177], v[48:49], v[20:21]
  v_pk_fma_f32 v[22:23], v[192:193], v[48:49], v[22:23]
  v_pk_fma_f32 v[24:25], v[208:209], v[48:49], v[24:25]
  v_pk_fma_f32 v[26:27], v[224:225], v[48:49], v[26:27]
  v_pk_fma_f32 v[28:29], v[240:241], v[48:49], v[28:29]
  v_pk_fma_f32 v[18:19], v[162:163], v[50:51], v[18:19]
  v_pk_fma_f32 v[20:21], v[178:179], v[50:51], v[20:21]
  v_pk_fma_f32 v[22:23], v[194:195], v[50:51], v[22:23]
  v_pk_fma_f32 v[24:25], v[210:211], v[50:51], v[24:25]
  v_pk_fma_f32 v[26:27], v[226:227], v[50:51], v[26:27]
  v_pk_fma_f32 v[28:29], v[242:243], v[50:51], v[28:29]
  v_pk_fma_f32 v[18:19], v[164:165], v[52:53], v[18:19]
  v_pk_fma_f32 v[20:21], v[180:181], v[52:53], v[20:21]
  v_pk_fma_f32 v[22:23], v[196:197], v[52:53], v[22:23]
  v_pk_fma_f32 v[24:25], v[212:213], v[52:53], v[24:25]
  v_pk_fma_f32 v[26:27], v[228:229], v[52:53], v[26:27]
  v_pk_fma_f32 v[28:29], v[244:245], v[52:53], v[28:29]
  v_pk_fma_f32 v[18:19], v[166:167], v[54:55], v[18:19]
  v_pk_fma_f32 v[20:21], v[182:183], v[54:55], v[20:21]
  v_pk_fma_f32 v[22:23], v[198:199], v[54:55], v[22:23]
  v_pk_fma_f32 v[24:25], v[214:215], v[54:55], v[24:25]
  v_pk_fma_f32 v[26:27], v[230:231], v[54:55], v[26:27]
  v_pk_fma_f32 v[28:29], v[246:247], v[54:55], v[28:29]
  v_pk_fma_f32 v[18:19], v[168:169], v[56:57], v[18:19]
  v_pk_fma_f32 v[20:21], v[184:185], v[56:57], v[20:21]
  v_pk_fma_f32 v[22:23], v[200:201], v[56:57], v[22:23]
  v_pk_fma_f32 v[24:25], v[216:217], v[56:57], v[24:25]
  v_pk_fma_f32 v[26:27], v[232:233], v[56:57], v[26:27]
  v_pk_fma_f32 v[28:29], v[248:249], v[56:57], v[28:29]
  v_pk_fma_f32 v[18:19], v[170:171], v[58:59], v[18:19]
  v_pk_fma_f32 v[20:21], v[186:187], v[58:59], v[20:21]
  v_pk_fma_f32 v[22:23], v[202:203], v[58:59], v[22:23]
  v_pk_fma_f32 v[24:25], v[218:219], v[58:59], v[24:25]
  v_pk_fma_f32 v[26:27], v[234:235], v[58:59], v[26:27]
  v_pk_fma_f32 v[28:29], v[250:251], v[58:59], v[28:29]
  s_waitcnt vmcnt(20)
  ds_read_b64_tr_b16 a[0:1], v12 offset:6144
  ds_read_b64_tr_b16 a[2:3], v13 offset:6208
  ds_read_b64_tr_b16 a[4:5], v12 offset:6272
  ds_read_b64_tr_b16 a[6:7], v12 offset:7680
  ds_read_b64_tr_b16 a[8:9], v13 offset:7744
  ds_read_b64_tr_b16 a[10:11], v12 offset:7808
  ds_read_b64_tr_b16 a[12:13], v12 offset:9216
  ds_read_b64_tr_b16 a[14:15], v13 offset:9280
  ds_read_b64_tr_b16 a[16:17], v12 offset:9344
  ds_read_b64_tr_b16 a[18:19], v12 offset:10752
  ds_read_b64_tr_b16 a[20:21], v13 offset:10816
  ds_read_b64_tr_b16 a[22:23], v12 offset:10880
  v_pk_fma_f32 v[18:19], v[172:173], v[60:61], v[18:19]
  v_pk_fma_f32 v[20:21], v[188:189], v[60:61], v[20:21]
  v_pk_fma_f32 v[22:23], v[204:205], v[60:61], v[22:23]
  v_pk_fma_f32 v[24:25], v[220:221], v[60:61], v[24:25]
  v_pk_fma_f32 v[26:27], v[236:237], v[60:61], v[26:27]
  v_pk_fma_f32 v[28:29], v[252:253], v[60:61], v[28:29]
  v_pk_fma_f32 v[18:19], v[174:175], v[62:63], v[18:19]
  v_pk_fma_f32 v[20:21], v[190:191], v[62:63], v[20:21]
  v_pk_fma_f32 v[22:23], v[206:207], v[62:63], v[22:23]
  v_pk_fma_f32 v[24:25], v[222:223], v[62:63], v[24:25]
  v_pk_fma_f32 v[26:27], v[238:239], v[62:63], v[26:27]
  v_pk_fma_f32 v[28:29], v[254:255], v[62:63], v[28:29]
  v_add_f32 v18, v18, v19
  v_add_f32 v20, v20, v21
  s_waitcnt lgkmcnt(11)
  v_mfma_f32_4x4x4_16b_bf16 v[2:5], a[136:137], a[0:1], 0
  s_waitcnt lgkmcnt(10)
  v_mfma_f32_4x4x4_16b_bf16 v[6:9], a[136:137], a[2:3], 0
  s_waitcnt lgkmcnt(9)
  v_mfma_f32_4x4x4_16b_bf16 v[14:17], a[136:137], a[4:5], 0
  s_waitcnt lgkmcnt(8)
  v_mfma_f32_4x4x4_16b_bf16 v[2:5], a[138:139], a[6:7], v[2:5]
  s_waitcnt lgkmcnt(7)
  v_mfma_f32_4x4x4_16b_bf16 v[6:9], a[138:139], a[8:9], v[6:9]
  s_waitcnt lgkmcnt(6)
  v_mfma_f32_4x4x4_16b_bf16 v[14:17], a[138:139], a[10:11], v[14:17]
  s_waitcnt lgkmcnt(5)
  v_mfma_f32_4x4x4_16b_bf16 v[2:5], a[140:141], a[12:13], v[2:5]
  s_waitcnt lgkmcnt(4)
  v_mfma_f32_4x4x4_16b_bf16 v[6:9], a[140:141], a[14:15], v[6:9]
  s_waitcnt lgkmcnt(3)
  v_mfma_f32_4x4x4_16b_bf16 v[14:17], a[140:141], a[16:17], v[14:17]
  s_waitcnt lgkmcnt(2)
  v_mfma_f32_4x4x4_16b_bf16 v[2:5], a[142:143], a[18:19], v[2:5]
  s_waitcnt lgkmcnt(1)
  v_mfma_f32_4x4x4_16b_bf16 v[6:9], a[142:143], a[20:21], v[6:9]
  s_waitcnt lgkmcnt(0)
  v_mfma_f32_4x4x4_16b_bf16 v[14:17], a[142:143], a[22:23], v[14:17]
  s_waitcnt vmcnt(6)
  ds_read_b64_tr_b16 a[224:225], v12 offset:12288
  ds_read_b64_tr_b16 a[226:227], v13 offset:12352
  ds_read_b64_tr_b16 a[228:229], v12 offset:12416
  ds_read_b64_tr_b16 a[230:231], v12 offset:13824
  ds_read_b64_tr_b16 a[232:233], v13 offset:13888
  ds_read_b64_tr_b16 a[234:235], v12 offset:13952
  ds_read_b64_tr_b16 a[236:237], v12 offset:15360
  ds_read_b64_tr_b16 a[238:239], v13 offset:15424
  ds_read_b64_tr_b16 a[240:241], v12 offset:15488
  ds_read_b64_tr_b16 a[242:243], v12 offset:16896
  ds_read_b64_tr_b16 a[244:245], v13 offset:16960
  ds_read_b64_tr_b16 a[246:247], v12 offset:17024
  v_add_f32 v22, v22, v23
  v_add_f32 v24, v24, v25
  v_add_f32 v26, v26, v27
  v_add_f32 v28, v28, v29
  s_nop 1
  v_permlane32_swap_b32 v18, v24
  v_permlane32_swap_b32 v20, v26
  v_permlane32_swap_b32 v22, v28
  v_add_f32 v18, v18, v24
  v_add_f32 v20, v20, v26
  v_add_f32 v22, v22, v28
  v_mul_f32 v18, v18, v31
  v_mul_f32 v20, v20, v31
  v_mul_f32 v22, v22, v31
  s_waitcnt lgkmcnt(11)
  v_mfma_f32_4x4x4_16b_bf16 v[2:5], a[144:145], a[224:225], v[2:5]
  s_waitcnt lgkmcnt(10)
  v_mfma_f32_4x4x4_16b_bf16 v[6:9], a[144:145], a[226:227], v[6:9]
  s_waitcnt lgkmcnt(9)
  v_mfma_f32_4x4x4_16b_bf16 v[14:17], a[144:145], a[228:229], v[14:17]
  s_waitcnt lgkmcnt(8)
  v_mfma_f32_4x4x4_16b_bf16 v[2:5], a[146:147], a[230:231], v[2:5]
  s_waitcnt lgkmcnt(7)
  v_mfma_f32_4x4x4_16b_bf16 v[6:9], a[146:147], a[232:233], v[6:9]
  s_waitcnt lgkmcnt(6)
  v_mfma_f32_4x4x4_16b_bf16 v[14:17], a[146:147], a[234:235], v[14:17]
  s_waitcnt lgkmcnt(5)
  v_mfma_f32_4x4x4_16b_bf16 v[2:5], a[148:149], a[236:237], v[2:5]
  s_waitcnt lgkmcnt(4)
  v_mfma_f32_4x4x4_16b_bf16 v[6:9], a[148:149], a[238:239], v[6:9]
  s_waitcnt lgkmcnt(3)
  v_mfma_f32_4x4x4_16b_bf16 v[14:17], a[148:149], a[240:241], v[14:17]
  s_waitcnt lgkmcnt(2)
  v_mfma_f32_4x4x4_16b_bf16 v[2:5], a[150:151], a[242:243], v[2:5]
  s_waitcnt lgkmcnt(1)
  v_mfma_f32_4x4x4_16b_bf16 v[6:9], a[150:151], a[244:245], v[6:9]
  s_waitcnt lgkmcnt(0)
  v_mfma_f32_4x4x4_16b_bf16 v[14:17], a[150:151], a[246:247], v[14:17]
  v_mov_b32 v24, 147460
  v_mov_b32 v25, 1
  v_lshlrev_b32 v19, 4, v0
  v_min_u32 v23, 752, v19
  v_add_u32 v23, 144384, v23
  v_add_f32 v2, v2, v18
  v_add_f32 v6, v6, v20
  v_add_f32 v14, v14, v22
  s_waitcnt vmcnt(4)
  ds_read_b64_tr_b16 a[0:1], v12 offset:0
  ds_read_b64_tr_b16 a[2:3], v13 offset:64
  ds_read_b64_tr_b16 a[4:5], v12 offset:128
  s_waitcnt vmcnt(3)
  ds_read_b64_tr_b16 a[6:7], v12 offset:1536
  ds_read_b64_tr_b16 a[8:9], v13 offset:1600
  ds_read_b64_tr_b16 a[10:11], v12 offset:1664
  s_waitcnt lgkmcnt(5)
  v_mfma_f32_4x4x4_16b_bf16 v[2:5], a[152:153], a[0:1], v[2:5]
  s_waitcnt lgkmcnt(4)
  v_mfma_f32_4x4x4_16b_bf16 v[6:9], a[152:153], a[2:3], v[6:9]
  s_waitcnt lgkmcnt(3)
  v_mfma_f32_4x4x4_16b_bf16 v[14:17], a[152:153], a[4:5], v[14:17]
  s_waitcnt vmcnt(1)
  ds_read_b64_tr_b16 a[12:13], v12 offset:3072
  ds_read_b64_tr_b16 a[14:15], v13 offset:3136
  ds_read_b64_tr_b16 a[16:17], v12 offset:3200
  s_waitcnt lgkmcnt(5)
  v_mfma_f32_4x4x4_16b_bf16 v[2:5], a[154:155], a[6:7], v[2:5]
  s_waitcnt lgkmcnt(4)
  v_mfma_f32_4x4x4_16b_bf16 v[6:9], a[154:155], a[8:9], v[6:9]
  s_waitcnt lgkmcnt(3)
  v_mfma_f32_4x4x4_16b_bf16 v[14:17], a[154:155], a[10:11], v[14:17]
  s_waitcnt vmcnt(0)
  ds_read_b64_tr_b16 a[18:19], v12 offset:4608
  ds_read_b64_tr_b16 a[20:21], v13 offset:4672
  ds_read_b64_tr_b16 a[22:23], v12 offset:4736
  s_waitcnt lgkmcnt(5)
  v_mfma_f32_4x4x4_16b_bf16 v[2:5], a[156:157], a[12:13], v[2:5]
  s_waitcnt lgkmcnt(4)
  v_mfma_f32_4x4x4_16b_bf16 v[6:9], a[156:157], a[14:15], v[6:9]
  s_waitcnt lgkmcnt(3)
  v_mfma_f32_4x4x4_16b_bf16 v[14:17], a[156:157], a[16:17], v[14:17]
  s_waitcnt lgkmcnt(2)
  v_mfma_f32_4x4x4_16b_bf16 v[2:5], a[158:159], a[18:19], v[2:5]
  s_waitcnt lgkmcnt(1)
  v_mfma_f32_4x4x4_16b_bf16 v[6:9], a[158:159], a[20:21], v[6:9]
  s_waitcnt lgkmcnt(0)
  v_mfma_f32_4x4x4_16b_bf16 v[14:17], a[158:159], a[22:23], v[14:17]
  s_nop 0
  v_add_f32 v18, v2, v3
  ds_write_b32 v11, v18 offset:0
  v_add_f32 v20, v6, v7
  ds_write_b32 v11, v20 offset:128
  v_add_f32 v22, v14, v15
  ds_write_b32 v11, v22 offset:256
  s_mov_b64 exec, 1
  ds_add_rtn_u32 v25, v24, v25
  s_mov_b64 exec, -1
  ds_read_b128 v[32:35], v23 offset:0
  ds_read_b128 v[36:39], v23 offset:768
  ds_read_b128 v[40:43], v23 offset:1536
  ds_read_b128 v[44:47], v23 offset:2304
  s_waitcnt lgkmcnt(4)
  v_readfirstlane_b32 s60, v25
  s_cmp_eq_u32 s60, 3
  s_cbranch_scc0 L_fin
  s_mov_b32 exec_lo, -1
  s_mov_b32 exec_hi, 0xffff
  s_cmp_eq_u32 s61, 0
  s_cbranch_scc1 L_cons
  s_waitcnt lgkmcnt(0)
  v_pk_add_f32 v[32:33], v[32:33], v[36:37]
  v_pk_add_f32 v[40:41], v[40:41], v[44:45]
  v_pk_add_f32 v[34:35], v[34:35], v[38:39]
  v_pk_add_f32 v[42:43], v[42:43], v[46:47]
  v_pk_add_f32 v[32:33], v[32:33], v[40:41]
  v_pk_add_f32 v[34:35], v[34:35], v[42:43]
  buffer_store_dwordx4 v[32:35], v19, s[40:43], s64 offen sc1
  s_branch L_fin
L_cons:
  v_mov_b32 v24, v19
  v_add_u32 v25, 4096, v19
  buffer_load_dwordx4 v[68:71], v24, s[40:43], s64 offen offset:768 sc1
  buffer_load_dwordx4 v[72:75], v24, s[40:43], s64 offen offset:1536 sc1
  buffer_load_dwordx4 v[76:79], v24, s[40:43], s64 offen offset:2304 sc1
  buffer_load_dwordx4 v[80:83], v24, s[40:43], s64 offen offset:3072 sc1
  buffer_load_dwordx4 v[84:87], v24, s[40:43], s64 offen offset:3840 sc1
  buffer_load_dwordx4 v[88:91], v25, s[40:43], s64 offen offset:512 sc1
  buffer_load_dwordx4 v[92:95], v25, s[40:43], s64 offen offset:1280 sc1
  buffer_load_dwordx4 v[100:103], v24, s[40:43], s64 offen offset:768 sc1
  buffer_load_dwordx4 v[104:107], v24, s[40:43], s64 offen offset:1536 sc1
  buffer_load_dwordx4 v[108:111], v24, s[40:43], s64 offen offset:2304 sc1
  buffer_load_dwordx4 v[112:115], v24, s[40:43], s64 offen offset:3072 sc1
  buffer_load_dwordx4 v[116:119], v24, s[40:43], s64 offen offset:3840 sc1
  buffer_load_dwordx4 v[120:123], v25, s[40:43], s64 offen offset:512 sc1
  buffer_load_dwordx4 v[124:127], v25, s[40:43], s64 offen offset:1280 sc1
  buffer_load_dwordx4 v[132:135], v24, s[40:43], s64 offen offset:768 sc1
  buffer_load_dwordx4 v[136:139], v24, s[40:43], s64 offen offset:1536 sc1
  buffer_load_dwordx4 v[140:143], v24, s[40:43], s64 offen offset:2304 sc1
  buffer_load_dwordx4 v[144:147], v24, s[40:43], s64 offen offset:3072 sc1
  buffer_load_dwordx4 v[148:151], v24, s[40:43], s64 offen offset:3840 sc1
  buffer_load_dwordx4 v[152:155], v25, s[40:43], s64 offen offset:512 sc1
  buffer_load_dwordx4 v[156:159], v25, s[40:43], s64 offen offset:1280 sc1
  s_waitcnt lgkmcnt(0)
  v_pk_add_f32 v[32:33], v[32:33], v[36:37]
  v_pk_add_f32 v[40:41], v[40:41], v[44:45]
  v_pk_add_f32 v[34:35], v[34:35], v[38:39]
  v_pk_add_f32 v[42:43], v[42:43], v[46:47]
  v_pk_add_f32 v[32:33], v[32:33], v[40:41]
  v_pk_add_f32 v[34:35], v[34:35], v[42:43]
  v_lshlrev_b32 v22, 3, v0
  s_mul_i32 s60, s62, 384
  s_mov_b32 s66, 0
L_poll:
  s_waitcnt vmcnt(19)
  v_pk_add_f32 v[40:41], v[68:69], v[72:73]
  v_pk_add_f32 v[42:43], v[70:71], v[74:75]
  s_waitcnt vmcnt(17)
  v_pk_add_f32 v[44:45], v[76:77], v[80:81]
  v_pk_add_f32 v[46:47], v[78:79], v[82:83]
  v_pk_add_f32 v[40:41], v[40:41], v[32:33]
  v_pk_add_f32 v[42:43], v[42:43], v[34:35]
  v_pk_add_f32 v[40:41], v[40:41], v[44:45]
  v_pk_add_f32 v[42:43], v[42:43], v[46:47]
  s_waitcnt vmcnt(15)
  v_pk_add_f32 v[44:45], v[84:85], v[88:89]
  v_pk_add_f32 v[46:47], v[86:87], v[90:91]
  v_pk_add_f32 v[40:41], v[40:41], v[44:45]
  v_pk_add_f32 v[42:43], v[42:43], v[46:47]
  s_waitcnt vmcnt(14)
  v_pk_add_f32 v[40:41], v[40:41], v[92:93]
  v_pk_add_f32 v[42:43], v[42:43], v[94:95]
  v_cmp_u_f32 vcc, v40, v41
  v_cmp_u_f32 s[68:69], v42, v43
  s_or_b64 vcc, vcc, s[68:69]
  s_cbranch_scc0 L_out
  buffer_load_dwordx4 v[68:71], v24, s[40:43], s64 offen offset:768 sc1
  buffer_load_dwordx4 v[72:75], v24, s[40:43], s64 offen offset:1536 sc1
  buffer_load_dwordx4 v[76:79], v24, s[40:43], s64 offen offset:2304 sc1
  buffer_load_dwordx4 v[80:83], v24, s[40:43], s64 offen offset:3072 sc1
  buffer_load_dwordx4 v[84:87], v24, s[40:43], s64 offen offset:3840 sc1
  buffer_load_dwordx4 v[88:91], v25, s[40:43], s64 offen offset:512 sc1
  buffer_load_dwordx4 v[92:95], v25, s[40:43], s64 offen offset:1280 sc1
  s_waitcnt vmcnt(19)
  v_pk_add_f32 v[40:41], v[100:101], v[104:105]
  v_pk_add_f32 v[42:43], v[102:103], v[106:107]
  s_waitcnt vmcnt(17)
  v_pk_add_f32 v[44:45], v[108:109], v[112:113]
  v_pk_add_f32 v[46:47], v[110:111], v[114:115]
  v_pk_add_f32 v[40:41], v[40:41], v[32:33]
  v_pk_add_f32 v[42:43], v[42:43], v[34:35]
  v_pk_add_f32 v[40:41], v[40:41], v[44:45]
  v_pk_add_f32 v[42:43], v[42:43], v[46:47]
  s_waitcnt vmcnt(15)
  v_pk_add_f32 v[44:45], v[116:117], v[120:121]
  v_pk_add_f32 v[46:47], v[118:119], v[122:123]
  v_pk_add_f32 v[40:41], v[40:41], v[44:45]
  v_pk_add_f32 v[42:43], v[42:43], v[46:47]
  s_waitcnt vmcnt(14)
  v_pk_add_f32 v[40:41], v[40:41], v[124:125]
  v_pk_add_f32 v[42:43], v[42:43], v[126:127]
  v_cmp_u_f32 vcc, v40, v41
  v_cmp_u_f32 s[68:69], v42, v43
  s_or_b64 vcc, vcc, s[68:69]
  s_cbranch_scc0 L_out
  buffer_load_dwordx4 v[100:103], v24, s[40:43], s64 offen offset:768 sc1
  buffer_load_dwordx4 v[104:107], v24, s[40:43], s64 offen offset:1536 sc1
  buffer_load_dwordx4 v[108:111], v24, s[40:43], s64 offen offset:2304 sc1
  buffer_load_dwordx4 v[112:115], v24, s[40:43], s64 offen offset:3072 sc1
  buffer_load_dwordx4 v[116:119], v24, s[40:43], s64 offen offset:3840 sc1
  buffer_load_dwordx4 v[120:123], v25, s[40:43], s64 offen offset:512 sc1
  buffer_load_dwordx4 v[124:127], v25, s[40:43], s64 offen offset:1280 sc1
  s_waitcnt vmcnt(19)
  v_pk_add_f32 v[40:41], v[132:133], v[136:137]
  v_pk_add_f32 v[42:43], v[134:135], v[138:139]
  s_waitcnt vmcnt(17)
  v_pk_add_f32 v[44:45], v[140:141], v[144:145]
  v_pk_add_f32 v[46:47], v[142:143], v[146:147]
  v_pk_add_f32 v[40:41], v[40:41], v[32:33]
  v_pk_add_f32 v[42:43], v[42:43], v[34:35]
  v_pk_add_f32 v[40:41], v[40:41], v[44:45]
  v_pk_add_f32 v[42:43], v[42:43], v[46:47]
  s_waitcnt vmcnt(15)
  v_pk_add_f32 v[44:45], v[148:149], v[152:153]
  v_pk_add_f32 v[46:47], v[150:151], v[154:155]
  v_pk_add_f32 v[40:41], v[40:41], v[44:45]
  v_pk_add_f32 v[42:43], v[42:43], v[46:47]
  s_waitcnt vmcnt(14)
  v_pk_add_f32 v[40:41], v[40:41], v[156:157]
  v_pk_add_f32 v[42:43], v[42:43], v[158:159]
  v_cmp_u_f32 vcc, v40, v41
  v_cmp_u_f32 s[68:69], v42, v43
  s_or_b64 vcc, vcc, s[68:69]
  s_cbranch_scc0 L_out
  buffer_load_dwordx4 v[132:135], v24, s[40:43], s64 offen offset:768 sc1
  buffer_load_dwordx4 v[136:139], v24, s[40:43], s64 offen offset:1536 sc1
  buffer_load_dwordx4 v[140:143], v24, s[40:43], s64 offen offset:2304 sc1
  buffer_load_dwordx4 v[144:147], v24, s[40:43], s64 offen offset:3072 sc1
  buffer_load_dwordx4 v[148:151], v24, s[40:43], s64 offen offset:3840 sc1
  buffer_load_dwordx4 v[152:155], v25, s[40:43], s64 offen offset:512 sc1
  buffer_load_dwordx4 v[156:159], v25, s[40:43], s64 offen offset:1280 sc1
  s_add_u32 s66, s66, 1
  s_cmp_lt_u32 s66, 20000
  s_cbranch_scc1 L_poll
L_out:
  v_cvt_pk_bf16_f32 v36, v40, v41
  v_cvt_pk_bf16_f32 v37, v42, v43
  buffer_store_dwordx2 v[36:37], v22, s[44:47], s60 offen sc1
L_fin:
L_end:
  s_endpgm
L_pslow:
  s_mov_b32 s67, 1
  s_and_b32 s60, s2, 0xf8
  s_lshl_b32 s60, s60, 9
  v_lshlrev_b32 v22, 3, v0
  buffer_load_dwordx2 a[192:193], v22, s[40:43], s60 offen offset:0 sc1
  buffer_load_dwordx2 a[194:195], v22, s[40:43], s60 offen offset:512 sc1
  buffer_load_dwordx2 a[196:197], v22, s[40:43], s60 offen offset:1024 sc1
  buffer_load_dwordx2 a[198:199], v22, s[40:43], s60 offen offset:1536 sc1
  buffer_load_dwordx2 a[200:201], v22, s[40:43], s60 offen offset:2048 sc1
  buffer_load_dwordx2 a[202:203], v22, s[40:43], s60 offen offset:2560 sc1
  buffer_load_dwordx2 a[204:205], v22, s[40:43], s60 offen offset:3072 sc1
  buffer_load_dwordx2 a[206:207], v22, s[40:43], s60 offen offset:3584 sc1
  s_add_u32 m0, s58, 16384
  s_add_u32 s57, s56, 67584
  buffer_load_dwordx4 v7, s[12:15], s57 offen offset:0 sc0 nt lds
  buffer_load_dwordx4 v8, s[12:15], s57 offen offset:1024 sc0 nt lds
  buffer_load_dwordx4 v9, s[12:15], s57 offen offset:2048 sc0 nt lds
  s_add_u32 m0, s58, 19456
  s_add_u32 s57, s56, 70656
  buffer_load_dwordx4 v7, s[12:15], s57 offen offset:0 sc0 nt lds
  buffer_load_dwordx4 v8, s[12:15], s57 offen offset:1024 sc0 nt lds
  buffer_load_dwordx4 v9, s[12:15], s57 offen offset:2048 sc0 nt lds
  ds_read_b64_tr_b16 a[48:49], v2 offset:0
  ds_read_b64_tr_b16 a[50:51], v3 offset:512
  ds_read_b64_tr_b16 a[64:65], v4 offset:0
  ds_read_b64_tr_b16 a[66:67], v5 offset:512
  ds_read_b64_tr_b16 a[52:53], v2 offset:2048
  ds_read_b64_tr_b16 a[54:55], v3 offset:2560
  ds_read_b64_tr_b16 a[68:69], v4 offset:2048
  ds_read_b64_tr_b16 a[70:71], v5 offset:2560
  ds_read_b64_tr_b16 a[56:57], v2 offset:4096
  ds_read_b64_tr_b16 a[58:59], v3 offset:4608
  ds_read_b64_tr_b16 a[72:73], v4 offset:4096
  ds_read_b64_tr_b16 a[74:75], v5 offset:4608
  ds_read_b64_tr_b16 a[60:61], v2 offset:6144
  ds_read_b64_tr_b16 a[62:63], v3 offset:6656
  ds_read_b64_tr_b16 a[76:77], v4 offset:6144
  ds_read_b64_tr_b16 a[78:79], v5 offset:6656
  s_waitcnt vmcnt(20)
  v_accvgpr_read_b32 v32, a176
  v_accvgpr_read_b32 v33, a177
  v_accvgpr_read_b32 v34, a178
  v_accvgpr_read_b32 v35, a179
  v_accvgpr_read_b32 v36, a180
  v_accvgpr_read_b32 v37, a181
  v_accvgpr_read_b32 v38, a182
  v_accvgpr_read_b32 v39, a183
  v_accvgpr_read_b32 v40, a184
  v_accvgpr_read_b32 v41, a185
  v_accvgpr_read_b32 v42, a186
  v_accvgpr_read_b32 v43, a187
  v_accvgpr_read_b32 v44, a188
  v_accvgpr_read_b32 v45, a189
  v_accvgpr_read_b32 v46, a190
  v_accvgpr_read_b32 v47, a191
  v_cmp_ne_u32 vcc, s65, v33
  v_cmp_ne_u32 s[68:69], s65, v35
  s_or_b64 vcc, vcc, s[68:69]
  v_cmp_ne_u32 s[68:69], s65, v37
  s_or_b64 vcc, vcc, s[68:69]
  v_cmp_ne_u32 s[68:69], s65, v39
  s_or_b64 vcc, vcc, s[68:69]
  v_cmp_ne_u32 s[68:69], s65, v41
  s_or_b64 vcc, vcc, s[68:69]
  v_cmp_ne_u32 s[68:69], s65, v43
  s_or_b64 vcc, vcc, s[68:69]
  v_cmp_ne_u32 s[68:69], s65, v45
  s_or_b64 vcc, vcc, s[68:69]
  v_cmp_ne_u32 s[68:69], s65, v47
  s_or_b64 vcc, vcc, s[68:69]
  s_mov_b32 s66, 0
  s_cmp_eq_u64 vcc, 0
  s_cbranch_scc1 L_sm_ok
  s_waitcnt vmcnt(6)
  v_accvgpr_read_b32 v32, a192
  v_accvgpr_read_b32 v33, a193
  v_accvgpr_read_b32 v34, a194
  v_accvgpr_read_b32 v35, a195
  v_accvgpr_read_b32 v36, a196
  v_accvgpr_read_b32 v37, a197
  v_accvgpr_read_b32 v38, a198
  v_accvgpr_read_b32 v39, a199
  v_accvgpr_read_b32 v40, a200
  v_accvgpr_read_b32 v41, a201
  v_accvgpr_read_b32 v42, a202
  v_accvgpr_read_b32 v43, a203
  v_accvgpr_read_b32 v44, a204
  v_accvgpr_read_b32 v45, a205
  v_accvgpr_read_b32 v46, a206
  v_accvgpr_read_b32 v47, a207
  s_mov_b32 s66, 0
L_sm_chk:
  v_cmp_ne_u32 vcc, s65, v33
  v_cmp_ne_u32 s[68:69], s65, v35
  s_or_b64 vcc, vcc, s[68:69]
  v_cmp_ne_u32 s[68:69], s65, v37
  s_or_b64 vcc, vcc, s[68:69]
  v_cmp_ne_u32 s[68:69], s65, v39
  s_or_b64 vcc, vcc, s[68:69]
  v_cmp_ne_u32 s[68:69], s65, v41
  s_or_b64 vcc, vcc, s[68:69]
  v_cmp_ne_u32 s[68:69], s65, v43
  s_or_b64 vcc, vcc, s[68:69]
  v_cmp_ne_u32 s[68:69], s65, v45
  s_or_b64 vcc, vcc, s[68:69]
  v_cmp_ne_u32 s[68:69], s65, v47
  s_or_b64 vcc, vcc, s[68:69]
  s_cmp_eq_u64 vcc, 0
  s_cbranch_scc1 L_sm_ok
  s_add_u32 s66, s66, 1
  s_cmp_ge_u32 s66, 20000
  s_cbranch_scc1 L_sm_ok
  s_and_b32 s60, s2, 0xf8
  s_lshl_b32 s60, s60, 9
  v_lshlrev_b32 v22, 3, v0
  buffer_load_dwordx2 v[32:33], v22, s[40:43], s60 offen offset:0 sc1
  buffer_load_dwordx2 v[34:35], v22, s[40:43], s60 offen offset:512 sc1
  buffer_load_dwordx2 v[36:37], v22, s[40:43], s60 offen offset:1024 sc1
  buffer_load_dwordx2 v[38:39], v22, s[40:43], s60 offen offset:1536 sc1
  buffer_load_dwordx2 v[40:41], v22, s[40:43], s60 offen offset:2048 sc1
  buffer_load_dwordx2 v[42:43], v22, s[40:43], s60 offen offset:2560 sc1
  buffer_load_dwordx2 v[44:45], v22, s[40:43], s60 offen offset:3072 sc1
  buffer_load_dwordx2 v[46:47], v22, s[40:43], s60 offen offset:3584 sc1
  s_waitcnt vmcnt(0)
  s_branch L_sm_chk
L_sm_ok:
  v_add_f32 v20, v32, v34
  v_add_f32 v21, v36, v38
  v_add_f32 v22, v40, v42
  v_add_f32 v23, v44, v46
  v_add_f32 v20, v20, v21
  v_mfma_f32_32x32x16_bf16 v[64:79], a[24:27], a[0:3], v[64:79]
  v_add_f32 v22, v22, v23
  v_add_f32 v20, v20, v22
  v_mul_f32 v20, 0x3dd53b95, v20
  v_mov_b32 v21, v20
  v_mfma_f32_32x32x16_bf16 v[160:175], a[28:31], a[0:3], v[160:175]
  s_nop 1
  v_max_f32_dpp v21, v21, v21 row_ror:8 row_mask:0xf bank_mask:0xf
  s_nop 1
  v_max_f32_dpp v21, v21, v21 row_ror:4 row_mask:0xf bank_mask:0xf
  v_mfma_f32_32x32x16_bf16 v[80:95], a[24:27], a[4:7], v[80:95]
  s_nop 1
  v_max_f32_dpp v21, v21, v21 row_ror:2 row_mask:0xf bank_mask:0xf
  s_nop 1
  v_max_f32_dpp v21, v21, v21 row_ror:1 row_mask:0xf bank_mask:0xf
  v_mfma_f32_32x32x16_bf16 v[176:191], a[28:31], a[4:7], v[176:191]
  v_mov_b32 v16, v21
  s_nop 1
  v_permlane16_swap_b32 v21, v16
  v_max_f32 v21, v21, v16
  v_mfma_f32_32x32x16_bf16 v[96:111], a[24:27], a[8:11], v[96:111]
  v_mov_b32 v16, v21
  s_nop 1
  v_permlane32_swap_b32 v21, v16
  v_max_f32 v21, v21, v16
  v_mfma_f32_32x32x16_bf16 v[192:207], a[28:31], a[8:11], v[192:207]
  v_sub_f32 v20, v20, v21
  v_exp_f32 v20, v20
  s_lshl_b32 s60, s3, 10
  s_add_u32 s60, s60, 140288
  v_mfma_f32_32x32x16_bf16 v[112:127], a[24:27], a[12:15], v[112:127]
  v_lshl_add_u32 v22, v0, 2, s60
  ds_write_b32 v22, v20
  v_and_b32 v23, 0xffff0000, v20
  v_sub_f32 v23, v20, v23
  v_mfma_f32_32x32x16_bf16 v[208:223], a[28:31], a[12:15], v[208:223]
  v_lshl_add_u32 v21, v0, 1, s60
  v_cvt_pk_bf16_f32 v23, v23, v23
  ds_write_b16_d16_hi v21, v20 offset:256
  ds_write_b16 v21, v23 offset:384
  v_mfma_f32_32x32x16_bf16 v[128:143], a[24:27], a[16:19], v[128:143]
  ds_read_b128 a[32:35], v1 offset:256
  ds_read_b128 a[36:39], v1 offset:288
  ds_read_b128 a[40:43], v1 offset:320
  ds_read_b128 a[44:47], v1 offset:352
  v_mfma_f32_32x32x16_bf16 v[224:239], a[28:31], a[16:19], v[224:239]
  ds_read_b128 v[32:35], v30 offset:0
  ds_read_b128 v[36:39], v30 offset:32
  ds_read_b128 v[40:43], v30 offset:64
  ds_read_b128 v[44:47], v30 offset:96
  v_mfma_f32_32x32x16_bf16 v[144:159], a[24:27], a[20:23], v[144:159]
  ds_read_b128 v[48:51], v30 offset:128
  ds_read_b128 v[52:55], v30 offset:160
  ds_read_b128 v[56:59], v30 offset:192
  ds_read_b128 v[60:63], v30 offset:224
  v_mfma_f32_32x32x16_bf16 v[240:255], a[28:31], a[20:23], v[240:255]
  s_waitcnt lgkmcnt(11)
  v_mfma_f32_32x32x16_bf16 a[80:95], a[32:35], a[48:51], 0
  v_mov_b32 v21, v20
  s_nop 1
  v_add_f32_dpp v21, v21, v21 row_ror:8 row_mask:0xf bank_mask:0xf
  s_nop 1
  v_mfma_f32_32x32x16_bf16 a[96:111], a[32:35], a[64:67], 0
  v_add_f32_dpp v21, v21, v21 row_ror:4 row_mask:0xf bank_mask:0xf
  s_nop 1
  v_add_f32_dpp v21, v21, v21 row_ror:2 row_mask:0xf bank_mask:0xf
  s_nop 1
  s_waitcnt lgkmcnt(10)
  v_mfma_f32_32x32x16_bf16 a[80:95], a[36:39], a[52:55], a[80:95]
  v_add_f32_dpp v21, v21, v21 row_ror:1 row_mask:0xf bank_mask:0xf
  v_mov_b32 v16, v21
  s_nop 1
  v_permlane16_swap_b32 v21, v16
  v_mfma_f32_32x32x16_bf16 a[96:111], a[36:39], a[68:71], a[96:111]
  v_add_f32 v21, v21, v16
  v_mov_b32 v16, v21
  s_nop 1
  v_permlane32_swap_b32 v21, v16
  s_waitcnt lgkmcnt(9)
  s_branch L_pjoin
.section .rodata,"a"
.p2align 6
.amdhsa_kernel standalone__low_rank_proj_linformer__decode_kernel
  .amdhsa_next_free_vgpr 504
  .amdhsa_next_free_sgpr 100
  .amdhsa_accum_offset 256
  .amdhsa_group_segment_fixed_size 0
  .amdhsa_kernarg_size 64
  .amdhsa_user_sgpr_count 2
  .amdhsa_user_sgpr_kernarg_segment_ptr 1
  .amdhsa_system_sgpr_workgroup_id_x 1
.end_amdhsa_kernel
```
